```python
import torch

def _softmax(x, axis=-1):
    return torch.softmax(x, dim=axis)
def _gelu(x):
    return torch.nn.functional.gelu(x, approximate="tanh")
def _silu(x):
    return torch.nn.functional.silu(x)
def _sigmoid(x):
    return torch.sigmoid(x)
def _layernorm(x, axis=-1, eps=1e-5):
    m = x.mean(dim=axis, keepdim=True)
    v = x.var(dim=axis, keepdim=True, unbiased=False)
    return (x - m) / torch.sqrt(v + eps)
def _scatter_add(tgt, idx, src, axis=0):
    return tgt.clone().index_add_(axis, idx, src)
def _segment_sum(src, seg, n):
    out = torch.zeros((n,) + src.shape[1:], dtype=src.dtype)
    return out.index_add_(0, seg, src)
def _pad(x, pw):
    flat = tuple(v for pair in reversed(pw) for v in pair)
    return torch.nn.functional.pad(x, flat)

kernel_name = 'sequential_preLN__ssm_conv_s4__glu_gated_glu__prompt'

def setup_inputs():

    _w = (lambda a: (lambda t: t.to(torch.bfloat16) if t.is_floating_point() else t)(torch.as_tensor(a)))
    def _A_setup():
        B, L, D, N = 1, 2048, 448, 256
        A_re = -(lambda _x: torch.exp(torch.as_tensor(_x)))((lambda *s: torch.randn(*s, dtype=torch.bfloat16) * 3.2)(D, N))
        A_im = torch.pi * (lambda *s: torch.randn(*s, dtype=torch.bfloat16) * 0.05)(D, N)
        B_re = (lambda *s: torch.randn(*s, dtype=torch.bfloat16) * 0.05)(D, N)
        B_im = (lambda *s: torch.randn(*s, dtype=torch.bfloat16) * 0.05)(D, N)
        C_re = (lambda *s: torch.randn(*s, dtype=torch.bfloat16) * 0.05)(D, N)
        C_im = (lambda *s: torch.randn(*s, dtype=torch.bfloat16) * 0.05)(D, N)
        log_dt = (lambda *s: torch.randn(*s, dtype=torch.bfloat16) * 0.05)(D) * 0.5 - 4.0
        Dskip = (lambda *s: torch.randn(*s, dtype=torch.bfloat16) * 0.05)(D)
        return {
            "u": _w((lambda *s: torch.randn(*s, dtype=torch.bfloat16) * 0.05)(B, L, D)),
            "A_re": _w(A_re),
            "A_im": _w(A_im),
            "B_re": _w(B_re),
            "B_im": _w(B_im),
            "C_re": _w(C_re),
            "C_im": _w(C_im),
            "log_dt": _w(log_dt),
            "Dskip": _w(Dskip),
        }
    _A_in = _A_setup()

    def _B_setup():
        B, S, D, F = 1, 2048, 448, 1792
        return {
            "x": _w((lambda *s: torch.randn(*s, dtype=torch.bfloat16) * 0.05)(B, S, D)),
            "w_gate": _w((lambda *s: torch.randn(*s, dtype=torch.bfloat16) * 0.05)(D, F)),
            "w_up": _w((lambda *s: torch.randn(*s, dtype=torch.bfloat16) * 0.05)(D, F)),
            "w_down": _w((lambda *s: torch.randn(*s, dtype=torch.bfloat16) * 0.05)(F, D)),
        }
    _B_in = _B_setup()

    return {
        "A_u": _A_in["u"],
        "A_A_re": _A_in["A_re"],
        "A_A_im": _A_in["A_im"],
        "A_B_re": _A_in["B_re"],
        "A_B_im": _A_in["B_im"],
        "A_C_re": _A_in["C_re"],
        "A_C_im": _A_in["C_im"],
        "A_log_dt": _A_in["log_dt"],
        "A_Dskip": _A_in["Dskip"],
        "B_x": _B_in["x"],
        "B_w_gate": _B_in["w_gate"],
        "B_w_up": _B_in["w_up"],
        "B_w_down": _B_in["w_down"],
    }

def reference(A_u, A_A_re, A_A_im, A_B_re, A_B_im, A_C_re, A_C_im, A_log_dt, A_Dskip, B_x, B_w_gate, B_w_up, B_w_down):
    def _A_ref(u, A_re, A_im, B_re, B_im, C_re, C_im, log_dt, Dskip):
        Bsz, L, D = u.shape
        dt = torch.exp(log_dt)[:, None]
        A = A_re + 1j * A_im
        Bc = B_re + 1j * B_im
        Cc = C_re + 1j * C_im
        logdA = dt * A
        dB = dt * Bc
        l = (lambda x, dt: x.to(dt))(torch.arange(L), A_re.dtype)
        P = torch.exp(logdA[:, :, None] * l[None, None, :])
        K = torch.einsum("dn,dnl,dn->dl", Cc, P, dB).real
        L2 = 2 * L
        Kp = _pad(K, ((0, 0), (0, L)))
        up = (lambda x, *d: x.permute(*d))(u, 0, 2, 1)
        up = _pad(up, ((0, 0), (0, 0), (0, L)))
        Kf = (lambda x, axes=(-2,-1): torch.fft.rfft2(x.float(), dim=axes))(Kp[:, None, :], axes=(-2, -1))
        Uf = (lambda x, axes=(-2,-1): torch.fft.rfft2(x.float(), dim=axes))(up[:, :, None, :], axes=(-2, -1))
        Yf = Uf * Kf[None, :, :, :]
        y = (lambda x, s, axes=(-2,-1): torch.fft.irfft2(x, s=s, dim=axes).to(torch.bfloat16))(Yf, (1, L2), axes=(-2, -1))[:, :, 0, :L]
        y = (lambda x, *d: x.permute(*d))(y, 0, 2, 1) + u * Dskip[None, None, :]
        return y

    def _B_ref(x, w_gate, w_up, w_down):
        g = torch.einsum("bsd,df->bsf", x, w_gate)
        u = torch.einsum("bsd,df->bsf", x, w_up)
        h = _sigmoid(g) * u
        return torch.einsum("bsf,fd->bsd", h, w_down)

    x = A_u
    h = x + _A_ref(_layernorm(x, axis=-1), A_A_re, A_A_im, A_B_re, A_B_im, A_C_re, A_C_im, A_log_dt, A_Dskip)
    h2 = h + _B_ref(_layernorm(h, axis=-1), B_w_gate, B_w_up, B_w_down)
    return h2
```

```asm
; @launch grid=(256,1,1) block=(512,1,1) lds=163840
.amdgcn_target "amdgcn-amd-amdhsa--gfx950"
.text
.globl sequential_preLN__ssm_conv_s4__glu_gated_glu__prompt_kernel
.p2align 8
.type sequential_preLN__ssm_conv_s4__glu_gated_glu__prompt_kernel,@function
sequential_preLN__ssm_conv_s4__glu_gated_glu__prompt_kernel:
L_kall_entry:
  s_cmp_ge_u32 s2, 256
  s_cbranch_scc1 L_kall_end
  s_load_dwordx16 s[4:19], s[0:1], 0
  s_load_dwordx2 s[20:21], s[0:1], 64
  s_load_dwordx4 s[24:27], s[0:1], 112
  s_load_dwordx4 s[28:31], s[0:1], 80
  v_lshrrev_b32 v2, 6, v0
  v_and_b32 v1, 63, v0
  v_readfirstlane_b32 s33, v2
  s_cmp_lt_u32 s2, 32
  s_cbranch_scc1 L_kall_spare
  s_sub_u32 s3, s2, 32
  s_cmp_ge_u32 s3, 8
  s_cbranch_scc1 L_kall_nopf
  s_cmp_lt_u32 s33, 4
  s_cbranch_scc1 L_kall_nopf
  s_getpc_b64 s[60:61]
L_kall_pca:
  s_add_u32 s60, s60, L_kall_entry-L_kall_pca
  s_addc_u32 s61, s61, -1
  v_subrev_u32 v3, 256, v0
  v_lshlrev_b32 v3, 4, v3
  v_mov_b32 v4, L_kall_last-L_kall_entry
  s_mov_b64 s[62:63], exec
  v_cmp_gt_u32 vcc, v4, v3
  s_nop 0
  s_and_b64 exec, s[62:63], vcc
  s_cbranch_execz L_kall_pfda
  global_load_dwordx4 v[200:203], v3, s[60:61]
  v_add_u32 v3, 4096, v3
  v_cmp_gt_u32 vcc, v4, v3
  s_nop 0
  s_and_b64 exec, s[62:63], vcc
  s_cbranch_execz L_kall_pfda
  global_load_dwordx4 v[204:207], v3, s[60:61]
  v_add_u32 v3, 4096, v3
  v_cmp_gt_u32 vcc, v4, v3
  s_nop 0
  s_and_b64 exec, s[62:63], vcc
  s_cbranch_execz L_kall_pfda
  global_load_dwordx4 v[208:211], v3, s[60:61]
  v_add_u32 v3, 4096, v3
  v_cmp_gt_u32 vcc, v4, v3
  s_nop 0
  s_and_b64 exec, s[62:63], vcc
  s_cbranch_execz L_kall_pfda
  global_load_dwordx4 v[212:215], v3, s[60:61]
  v_add_u32 v3, 4096, v3
  v_cmp_gt_u32 vcc, v4, v3
  s_nop 0
  s_and_b64 exec, s[62:63], vcc
  s_cbranch_execz L_kall_pfda
  global_load_dwordx4 v[200:203], v3, s[60:61]
  v_add_u32 v3, 4096, v3
  v_cmp_gt_u32 vcc, v4, v3
  s_nop 0
  s_and_b64 exec, s[62:63], vcc
  s_cbranch_execz L_kall_pfda
  global_load_dwordx4 v[204:207], v3, s[60:61]
  v_add_u32 v3, 4096, v3
  v_cmp_gt_u32 vcc, v4, v3
  s_nop 0
  s_and_b64 exec, s[62:63], vcc
  s_cbranch_execz L_kall_pfda
  global_load_dwordx4 v[208:211], v3, s[60:61]
  v_add_u32 v3, 4096, v3
L_kall_pfda:
  s_mov_b64 exec, s[62:63]
L_kall_nopf:
  s_and_b32 s34, s3, 7
  s_mul_i32 s34, s34, 56
  s_lshr_b32 s35, s3, 3
  s_lshl_b32 s35, s35, 1
  s_add_u32 s34, s34, s35
  s_bfe_u32 s35, s33, 0x10001
  s_and_b32 s36, s33, 1
  s_add_u32 s37, s34, s35
  s_lshr_b32 s52, s33, 2
  s_and_b32 s53, s33, 3
  s_lshl_b32 s38, s37, 9
  s_lshl_b32 s39, s36, 8
  s_add_u32 s38, s38, s39
  v_lshl_add_u32 v24, v1, 2, s38
  s_movk_i32 s39, 7168
  v_and_b32 v23, 255, v0
  v_mul_u32_u24 v25, s39, v23
  s_lshl_b32 s38, s34, 1
  s_add_u32 s39, s38, 3584
  v_add_u32 v25, s39, v25
  s_mul_i32 s42, s53, 27984
  v_lshl_add_u32 v26, v1, 3, s42
  s_waitcnt lgkmcnt(0)
  s_load_dword s40, s[18:19], s38
  s_load_dword s41, s[20:21], s38
  s_cmp_lg_u32 s52, 0
  s_cbranch_scc1 L_kall_noparam
  global_load_dword v10, v24, s[6:7]
  global_load_dword v11, v24, s[8:9]
  global_load_dword v12, v24, s[10:11]
  global_load_dword v13, v24, s[12:13]
  global_load_dword v14, v24, s[14:15]
  global_load_dword v15, v24, s[16:17]
  s_waitcnt vmcnt(0)
L_kall_noparam:
  v_mov_b32 v27, 0
  v_lshlrev_b32 v28, 2, v1
  v_add_u32 v28, 141632, v28
  s_mov_b64 s[50:51], exec
  s_mov_b64 exec, 0xffff
  ds_write_b32 v28, v27
  s_mov_b64 exec, s[50:51]
  s_waitcnt lgkmcnt(0)
  s_barrier
  s_mov_b32 s46, 0xffff0000
  s_waitcnt lgkmcnt(0)
  s_cmp_eq_u32 s35, 0
  s_cselect_b32 s43, 16, 0
  s_lshl_b32 s41, s41, s43
  s_and_b32 s41, s41, 0xffff0000
  s_cmp_lg_u32 s52, 0
  s_cbranch_scc1 L_kall_V
  s_lshl_b32 s40, s40, s43
  s_and_b32 s40, s40, 0xffff0000
  s_mov_b32 s44, 0x3fb8aa3b
  s_mov_b32 s45, 0x3e22f983
  v_mov_b32 v30, s40
  v_mul_f32 v30, s44, v30
  v_exp_f32 v30, v30
  s_nop 0
  v_cvt_pk_bf16_f32 v30, v30, v30
  v_and_b32 v30, s46, v30
  s_waitcnt vmcnt(0)
  v_lshlrev_b32 v32, 16, v10
  v_lshlrev_b32 v33, 16, v11
  v_lshlrev_b32 v44, 16, v12
  v_lshlrev_b32 v45, 16, v13
  v_lshlrev_b32 v46, 16, v14
  v_lshlrev_b32 v47, 16, v15
  v_and_b32 v76, s46, v10
  v_and_b32 v77, s46, v11
  v_and_b32 v88, s46, v12
  v_and_b32 v89, s46, v13
  v_and_b32 v90, s46, v14
  v_and_b32 v91, s46, v15
  v_pk_mul_f32 v[32:33], v[32:33], v[30:31] op_sel_hi:[1,0]
  v_pk_mul_f32 v[44:45], v[44:45], v[30:31] op_sel_hi:[1,0]
  v_pk_mul_f32 v[76:77], v[76:77], v[30:31] op_sel_hi:[1,0]
  v_pk_mul_f32 v[88:89], v[88:89], v[30:31] op_sel_hi:[1,0]
  v_pk_mul_f32 v[34:35], v[46:47], v[44:45] op_sel_hi:[1,0]
  v_pk_mul_f32 v[78:79], v[90:91], v[88:89] op_sel_hi:[1,0]
  v_pk_fma_f32 v[34:35], v[46:47], v[44:45], v[34:35] op_sel:[1,1,0] op_sel_hi:[0,1,1] neg_lo:[1,0,0]
  v_pk_fma_f32 v[78:79], v[90:91], v[88:89], v[78:79] op_sel:[1,1,0] op_sel_hi:[0,1,1] neg_lo:[1,0,0]
  v_mul_f32 v32, s44, v32
  v_mul_f32 v33, s45, v33
  v_mul_f32 v76, s44, v76
  v_mul_f32 v77, s45, v77
  v_mov_b32 v28, 0x41000000
  v_pk_mul_f32 v[62:63], v[32:33], v[28:29] op_sel_hi:[1,0]
  v_pk_mul_f32 v[106:107], v[76:77], v[28:29] op_sel_hi:[1,0]
  v_exp_f32 v62, v62
  v_fract_f32 v63, v63
  v_exp_f32 v106, v106
  v_fract_f32 v107, v107
  v_cos_f32 v64, v63
  v_sin_f32 v65, v63
  v_cos_f32 v108, v107
  v_sin_f32 v109, v107
  v_pk_mul_f32 v[64:65], v[64:65], v[62:63] op_sel_hi:[1,0]
  v_pk_mul_f32 v[108:109], v[108:109], v[106:107] op_sel_hi:[1,0]
  v_exp_f32 v62, v32
  v_fract_f32 v63, v33
  v_exp_f32 v106, v76
  v_fract_f32 v107, v77
  v_cos_f32 v36, v63
  v_sin_f32 v37, v63
  v_cos_f32 v80, v107
  v_sin_f32 v81, v107
  v_pk_mul_f32 v[36:37], v[36:37], v[62:63] op_sel_hi:[1,0]
  v_pk_mul_f32 v[80:81], v[80:81], v[106:107] op_sel_hi:[1,0]
  v_mov_b32 v28, 0x43800000
  v_pk_mul_f32 v[62:63], v[32:33], v[28:29] op_sel_hi:[1,0]
  v_pk_mul_f32 v[106:107], v[76:77], v[28:29] op_sel_hi:[1,0]
  v_exp_f32 v62, v62
  v_fract_f32 v63, v63
  v_exp_f32 v106, v106
  v_fract_f32 v107, v107
  v_cos_f32 v38, v63
  v_sin_f32 v39, v63
  v_cos_f32 v82, v107
  v_sin_f32 v83, v107
  v_pk_mul_f32 v[38:39], v[38:39], v[62:63] op_sel_hi:[1,0]
  v_pk_mul_f32 v[82:83], v[82:83], v[106:107] op_sel_hi:[1,0]
  v_mov_b32 v62, 1.0
  v_mov_b32 v63, 0
  v_mov_b32 v106, 1.0
  v_mov_b32 v107, 0
  v_cvt_pk_bf16_f32 v16, v62, v63
  v_cvt_pk_bf16_f32 v17, v106, v107
  ds_write_b64 v26, v[16:17] offset:11088
  v_cvt_pk_bf16_f32 v18, v64, v65
  v_cvt_pk_bf16_f32 v19, v108, v109
  ds_write_b64 v26, v[18:19] offset:11616
  v_cvt_pk_bf16_f32 v20, v34, -v35
  v_cvt_pk_bf16_f32 v21, v78, -v79
  ds_write_b64 v26, v[20:21] offset:0
  v_pk_mul_f32 v[66:67], v[64:65], v[64:65] op_sel_hi:[1,0]
  v_pk_mul_f32 v[110:111], v[108:109], v[108:109] op_sel_hi:[1,0]
  v_pk_mul_f32 v[44:45], v[34:35], v[36:37] op_sel_hi:[1,0]
  v_pk_mul_f32 v[88:89], v[78:79], v[80:81] op_sel_hi:[1,0]
  v_pk_mul_f32 v[48:49], v[34:35], v[38:39] op_sel_hi:[1,0]
  v_pk_mul_f32 v[92:93], v[78:79], v[82:83] op_sel_hi:[1,0]
  v_pk_mul_f32 v[40:41], v[36:37], v[36:37] op_sel_hi:[1,0]
  v_pk_mul_f32 v[84:85], v[80:81], v[80:81] op_sel_hi:[1,0]
  v_pk_fma_f32 v[66:67], v[64:65], v[64:65], v[66:67] op_sel:[1,1,0] op_sel_hi:[0,1,1] neg_lo:[1,0,0]
  v_pk_fma_f32 v[110:111], v[108:109], v[108:109], v[110:111] op_sel:[1,1,0] op_sel_hi:[0,1,1] neg_lo:[1,0,0]
  v_pk_fma_f32 v[44:45], v[34:35], v[36:37], v[44:45] op_sel:[1,1,0] op_sel_hi:[0,1,1] neg_lo:[1,0,0]
  v_pk_fma_f32 v[88:89], v[78:79], v[80:81], v[88:89] op_sel:[1,1,0] op_sel_hi:[0,1,1] neg_lo:[1,0,0]
  v_pk_fma_f32 v[48:49], v[34:35], v[38:39], v[48:49] op_sel:[1,1,0] op_sel_hi:[0,1,1] neg_lo:[1,0,0]
  v_pk_fma_f32 v[92:93], v[78:79], v[82:83], v[92:93] op_sel:[1,1,0] op_sel_hi:[0,1,1] neg_lo:[1,0,0]
  v_pk_fma_f32 v[40:41], v[36:37], v[36:37], v[40:41] op_sel:[1,1,0] op_sel_hi:[0,1,1] neg_lo:[1,0,0]
  v_pk_fma_f32 v[84:85], v[80:81], v[80:81], v[84:85] op_sel:[1,1,0] op_sel_hi:[0,1,1] neg_lo:[1,0,0]
  v_cvt_pk_bf16_f32 v22, v66, v67
  v_cvt_pk_bf16_f32 v23, v110, v111
  ds_write_b64 v26, v[22:23] offset:12144
  v_cvt_pk_bf16_f32 v16, v44, -v45
  v_cvt_pk_bf16_f32 v17, v88, -v89
  ds_write_b64 v26, v[16:17] offset:528
  v_cvt_pk_bf16_f32 v18, v48, -v49
  v_cvt_pk_bf16_f32 v19, v92, -v93
  ds_write_b64 v26, v[18:19] offset:4224
  v_pk_mul_f32 v[68:69], v[64:65], v[66:67] op_sel_hi:[1,0]
  v_pk_mul_f32 v[112:113], v[108:109], v[110:111] op_sel_hi:[1,0]
  v_pk_mul_f32 v[72:73], v[66:67], v[66:67] op_sel_hi:[1,0]
  v_pk_mul_f32 v[116:117], v[110:111], v[110:111] op_sel_hi:[1,0]
  v_pk_mul_f32 v[46:47], v[44:45], v[36:37] op_sel_hi:[1,0]
  v_pk_mul_f32 v[90:91], v[88:89], v[80:81] op_sel_hi:[1,0]
  v_pk_mul_f32 v[50:51], v[48:49], v[38:39] op_sel_hi:[1,0]
  v_pk_mul_f32 v[94:95], v[92:93], v[82:83] op_sel_hi:[1,0]
  v_pk_mul_f32 v[42:43], v[40:41], v[40:41] op_sel_hi:[1,0]
  v_pk_mul_f32 v[86:87], v[84:85], v[84:85] op_sel_hi:[1,0]
  v_pk_fma_f32 v[68:69], v[64:65], v[66:67], v[68:69] op_sel:[1,1,0] op_sel_hi:[0,1,1] neg_lo:[1,0,0]
  v_pk_fma_f32 v[112:113], v[108:109], v[110:111], v[112:113] op_sel:[1,1,0] op_sel_hi:[0,1,1] neg_lo:[1,0,0]
  v_pk_fma_f32 v[72:73], v[66:67], v[66:67], v[72:73] op_sel:[1,1,0] op_sel_hi:[0,1,1] neg_lo:[1,0,0]
  v_pk_fma_f32 v[116:117], v[110:111], v[110:111], v[116:117] op_sel:[1,1,0] op_sel_hi:[0,1,1] neg_lo:[1,0,0]
  v_pk_fma_f32 v[46:47], v[44:45], v[36:37], v[46:47] op_sel:[1,1,0] op_sel_hi:[0,1,1] neg_lo:[1,0,0]
  v_pk_fma_f32 v[90:91], v[88:89], v[80:81], v[90:91] op_sel:[1,1,0] op_sel_hi:[0,1,1] neg_lo:[1,0,0]
  v_pk_fma_f32 v[50:51], v[48:49], v[38:39], v[50:51] op_sel:[1,1,0] op_sel_hi:[0,1,1] neg_lo:[1,0,0]
  v_pk_fma_f32 v[94:95], v[92:93], v[82:83], v[94:95] op_sel:[1,1,0] op_sel_hi:[0,1,1] neg_lo:[1,0,0]
  v_pk_fma_f32 v[42:43], v[40:41], v[40:41], v[42:43] op_sel:[1,1,0] op_sel_hi:[0,1,1] neg_lo:[1,0,0]
  v_pk_fma_f32 v[86:87], v[84:85], v[84:85], v[86:87] op_sel:[1,1,0] op_sel_hi:[0,1,1] neg_lo:[1,0,0]
  v_cvt_pk_bf16_f32 v20, v68, v69
  v_cvt_pk_bf16_f32 v21, v112, v113
  ds_write_b64 v26, v[20:21] offset:12672
  v_cvt_pk_bf16_f32 v22, v72, v73
  v_cvt_pk_bf16_f32 v23, v116, v117
  ds_write_b64 v26, v[22:23] offset:13200
  v_cvt_pk_bf16_f32 v16, v46, -v47
  v_cvt_pk_bf16_f32 v17, v90, -v91
  ds_write_b64 v26, v[16:17] offset:1056
  v_cvt_pk_bf16_f32 v18, v50, -v51
  v_cvt_pk_bf16_f32 v19, v94, -v95
  ds_write_b64 v26, v[18:19] offset:4752
  v_pk_mul_f32 v[70:71], v[68:69], v[66:67] op_sel_hi:[1,0]
  v_pk_mul_f32 v[114:115], v[112:113], v[110:111] op_sel_hi:[1,0]
  v_pk_mul_f32 v[74:75], v[72:73], v[66:67] op_sel_hi:[1,0]
  v_pk_mul_f32 v[118:119], v[116:117], v[110:111] op_sel_hi:[1,0]
  v_pk_mul_f32 v[44:45], v[46:47], v[36:37] op_sel_hi:[1,0]
  v_pk_mul_f32 v[88:89], v[90:91], v[80:81] op_sel_hi:[1,0]
  v_pk_mul_f32 v[52:53], v[50:51], v[38:39] op_sel_hi:[1,0]
  v_pk_mul_f32 v[96:97], v[94:95], v[82:83] op_sel_hi:[1,0]
  v_pk_mul_f32 v[60:61], v[48:49], v[40:41] op_sel_hi:[1,0]
  v_pk_mul_f32 v[104:105], v[92:93], v[84:85] op_sel_hi:[1,0]
  v_pk_fma_f32 v[70:71], v[68:69], v[66:67], v[70:71] op_sel:[1,1,0] op_sel_hi:[0,1,1] neg_lo:[1,0,0]
  v_pk_fma_f32 v[114:115], v[112:113], v[110:111], v[114:115] op_sel:[1,1,0] op_sel_hi:[0,1,1] neg_lo:[1,0,0]
  v_pk_fma_f32 v[74:75], v[72:73], v[66:67], v[74:75] op_sel:[1,1,0] op_sel_hi:[0,1,1] neg_lo:[1,0,0]
  v_pk_fma_f32 v[118:119], v[116:117], v[110:111], v[118:119] op_sel:[1,1,0] op_sel_hi:[0,1,1] neg_lo:[1,0,0]
  v_pk_fma_f32 v[44:45], v[46:47], v[36:37], v[44:45] op_sel:[1,1,0] op_sel_hi:[0,1,1] neg_lo:[1,0,0]
  v_pk_fma_f32 v[88:89], v[90:91], v[80:81], v[88:89] op_sel:[1,1,0] op_sel_hi:[0,1,1] neg_lo:[1,0,0]
  v_pk_fma_f32 v[52:53], v[50:51], v[38:39], v[52:53] op_sel:[1,1,0] op_sel_hi:[0,1,1] neg_lo:[1,0,0]
  v_pk_fma_f32 v[96:97], v[94:95], v[82:83], v[96:97] op_sel:[1,1,0] op_sel_hi:[0,1,1] neg_lo:[1,0,0]
  v_pk_fma_f32 v[60:61], v[48:49], v[40:41], v[60:61] op_sel:[1,1,0] op_sel_hi:[0,1,1] neg_lo:[1,0,0]
  v_pk_fma_f32 v[104:105], v[92:93], v[84:85], v[104:105] op_sel:[1,1,0] op_sel_hi:[0,1,1] neg_lo:[1,0,0]
  v_cvt_pk_bf16_f32 v20, v70, v71
  v_cvt_pk_bf16_f32 v21, v114, v115
  ds_write_b64 v26, v[20:21] offset:13728
  v_cvt_pk_bf16_f32 v22, v74, v75
  v_cvt_pk_bf16_f32 v23, v118, v119
  ds_write_b64 v26, v[22:23] offset:14256
  v_cvt_pk_bf16_f32 v16, v44, -v45
  v_cvt_pk_bf16_f32 v17, v88, -v89
  ds_write_b64 v26, v[16:17] offset:1584
  v_cvt_pk_bf16_f32 v18, v52, -v53
  v_cvt_pk_bf16_f32 v19, v96, -v97
  ds_write_b64 v26, v[18:19] offset:5280
  v_cvt_pk_bf16_f32 v20, v60, -v61
  v_cvt_pk_bf16_f32 v21, v104, -v105
  ds_write_b64 v26, v[20:21] offset:8448
  v_pk_mul_f32 v[68:69], v[70:71], v[66:67] op_sel_hi:[1,0]
  v_pk_mul_f32 v[112:113], v[114:115], v[110:111] op_sel_hi:[1,0]
  v_pk_mul_f32 v[72:73], v[74:75], v[66:67] op_sel_hi:[1,0]
  v_pk_mul_f32 v[116:117], v[118:119], v[110:111] op_sel_hi:[1,0]
  v_pk_mul_f32 v[46:47], v[44:45], v[36:37] op_sel_hi:[1,0]
  v_pk_mul_f32 v[90:91], v[88:89], v[80:81] op_sel_hi:[1,0]
  v_pk_mul_f32 v[54:55], v[52:53], v[38:39] op_sel_hi:[1,0]
  v_pk_mul_f32 v[98:99], v[96:97], v[82:83] op_sel_hi:[1,0]
  v_pk_mul_f32 v[58:59], v[48:49], v[42:43] op_sel_hi:[1,0]
  v_pk_mul_f32 v[102:103], v[92:93], v[86:87] op_sel_hi:[1,0]
  v_pk_fma_f32 v[68:69], v[70:71], v[66:67], v[68:69] op_sel:[1,1,0] op_sel_hi:[0,1,1] neg_lo:[1,0,0]
  v_pk_fma_f32 v[112:113], v[114:115], v[110:111], v[112:113] op_sel:[1,1,0] op_sel_hi:[0,1,1] neg_lo:[1,0,0]
  v_pk_fma_f32 v[72:73], v[74:75], v[66:67], v[72:73] op_sel:[1,1,0] op_sel_hi:[0,1,1] neg_lo:[1,0,0]
  v_pk_fma_f32 v[116:117], v[118:119], v[110:111], v[116:117] op_sel:[1,1,0] op_sel_hi:[0,1,1] neg_lo:[1,0,0]
  v_pk_fma_f32 v[46:47], v[44:45], v[36:37], v[46:47] op_sel:[1,1,0] op_sel_hi:[0,1,1] neg_lo:[1,0,0]
  v_pk_fma_f32 v[90:91], v[88:89], v[80:81], v[90:91] op_sel:[1,1,0] op_sel_hi:[0,1,1] neg_lo:[1,0,0]
  v_pk_fma_f32 v[54:55], v[52:53], v[38:39], v[54:55] op_sel:[1,1,0] op_sel_hi:[0,1,1] neg_lo:[1,0,0]
  v_pk_fma_f32 v[98:99], v[96:97], v[82:83], v[98:99] op_sel:[1,1,0] op_sel_hi:[0,1,1] neg_lo:[1,0,0]
  v_pk_fma_f32 v[58:59], v[48:49], v[42:43], v[58:59] op_sel:[1,1,0] op_sel_hi:[0,1,1] neg_lo:[1,0,0]
  v_pk_fma_f32 v[102:103], v[92:93], v[86:87], v[102:103] op_sel:[1,1,0] op_sel_hi:[0,1,1] neg_lo:[1,0,0]
  v_cvt_pk_bf16_f32 v22, v68, v69
  v_cvt_pk_bf16_f32 v23, v112, v113
  ds_write_b64 v26, v[22:23] offset:14784
  v_cvt_pk_bf16_f32 v16, v72, v73
  v_cvt_pk_bf16_f32 v17, v116, v117
  ds_write_b64 v26, v[16:17] offset:15312
  v_cvt_pk_bf16_f32 v18, v46, -v47
  v_cvt_pk_bf16_f32 v19, v90, -v91
  ds_write_b64 v26, v[18:19] offset:2112
  v_cvt_pk_bf16_f32 v20, v54, -v55
  v_cvt_pk_bf16_f32 v21, v98, -v99
  ds_write_b64 v26, v[20:21] offset:5808
  v_cvt_pk_bf16_f32 v22, v58, -v59
  v_cvt_pk_bf16_f32 v23, v102, -v103
  ds_write_b64 v26, v[22:23] offset:8976
  v_pk_mul_f32 v[70:71], v[68:69], v[66:67] op_sel_hi:[1,0]
  v_pk_mul_f32 v[114:115], v[112:113], v[110:111] op_sel_hi:[1,0]
  v_pk_mul_f32 v[74:75], v[72:73], v[66:67] op_sel_hi:[1,0]
  v_pk_mul_f32 v[118:119], v[116:117], v[110:111] op_sel_hi:[1,0]
  v_pk_mul_f32 v[44:45], v[46:47], v[36:37] op_sel_hi:[1,0]
  v_pk_mul_f32 v[88:89], v[90:91], v[80:81] op_sel_hi:[1,0]
  v_pk_mul_f32 v[56:57], v[54:55], v[38:39] op_sel_hi:[1,0]
  v_pk_mul_f32 v[100:101], v[98:99], v[82:83] op_sel_hi:[1,0]
  v_pk_mul_f32 v[60:61], v[58:59], v[40:41] op_sel_hi:[1,0]
  v_pk_mul_f32 v[104:105], v[102:103], v[84:85] op_sel_hi:[1,0]
  v_pk_fma_f32 v[70:71], v[68:69], v[66:67], v[70:71] op_sel:[1,1,0] op_sel_hi:[0,1,1] neg_lo:[1,0,0]
  v_pk_fma_f32 v[114:115], v[112:113], v[110:111], v[114:115] op_sel:[1,1,0] op_sel_hi:[0,1,1] neg_lo:[1,0,0]
  v_pk_fma_f32 v[74:75], v[72:73], v[66:67], v[74:75] op_sel:[1,1,0] op_sel_hi:[0,1,1] neg_lo:[1,0,0]
  v_pk_fma_f32 v[118:119], v[116:117], v[110:111], v[118:119] op_sel:[1,1,0] op_sel_hi:[0,1,1] neg_lo:[1,0,0]
  v_pk_fma_f32 v[44:45], v[46:47], v[36:37], v[44:45] op_sel:[1,1,0] op_sel_hi:[0,1,1] neg_lo:[1,0,0]
  v_pk_fma_f32 v[88:89], v[90:91], v[80:81], v[88:89] op_sel:[1,1,0] op_sel_hi:[0,1,1] neg_lo:[1,0,0]
  v_pk_fma_f32 v[56:57], v[54:55], v[38:39], v[56:57] op_sel:[1,1,0] op_sel_hi:[0,1,1] neg_lo:[1,0,0]
  v_pk_fma_f32 v[100:101], v[98:99], v[82:83], v[100:101] op_sel:[1,1,0] op_sel_hi:[0,1,1] neg_lo:[1,0,0]
  v_pk_fma_f32 v[60:61], v[58:59], v[40:41], v[60:61] op_sel:[1,1,0] op_sel_hi:[0,1,1] neg_lo:[1,0,0]
  v_pk_fma_f32 v[104:105], v[102:103], v[84:85], v[104:105] op_sel:[1,1,0] op_sel_hi:[0,1,1] neg_lo:[1,0,0]
  v_cvt_pk_bf16_f32 v16, v70, v71
  v_cvt_pk_bf16_f32 v17, v114, v115
  ds_write_b64 v26, v[16:17] offset:15840
  v_cvt_pk_bf16_f32 v18, v74, v75
  v_cvt_pk_bf16_f32 v19, v118, v119
  ds_write_b64 v26, v[18:19] offset:16368
  v_cvt_pk_bf16_f32 v20, v44, -v45
  v_cvt_pk_bf16_f32 v21, v88, -v89
  ds_write_b64 v26, v[20:21] offset:2640
  v_cvt_pk_bf16_f32 v22, v56, -v57
  v_cvt_pk_bf16_f32 v23, v100, -v101
  ds_write_b64 v26, v[22:23] offset:6336
  v_cvt_pk_bf16_f32 v16, v60, -v61
  v_cvt_pk_bf16_f32 v17, v104, -v105
  ds_write_b64 v26, v[16:17] offset:9504
  v_pk_mul_f32 v[68:69], v[70:71], v[66:67] op_sel_hi:[1,0]
  v_pk_mul_f32 v[112:113], v[114:115], v[110:111] op_sel_hi:[1,0]
  v_pk_mul_f32 v[72:73], v[74:75], v[66:67] op_sel_hi:[1,0]
  v_pk_mul_f32 v[116:117], v[118:119], v[110:111] op_sel_hi:[1,0]
  v_pk_mul_f32 v[46:47], v[44:45], v[36:37] op_sel_hi:[1,0]
  v_pk_mul_f32 v[90:91], v[88:89], v[80:81] op_sel_hi:[1,0]
  v_pk_mul_f32 v[54:55], v[56:57], v[38:39] op_sel_hi:[1,0]
  v_pk_mul_f32 v[98:99], v[100:101], v[82:83] op_sel_hi:[1,0]
  v_pk_mul_f32 v[60:61], v[50:51], v[42:43] op_sel_hi:[1,0]
  v_pk_mul_f32 v[104:105], v[94:95], v[86:87] op_sel_hi:[1,0]
  v_pk_fma_f32 v[68:69], v[70:71], v[66:67], v[68:69] op_sel:[1,1,0] op_sel_hi:[0,1,1] neg_lo:[1,0,0]
  v_pk_fma_f32 v[112:113], v[114:115], v[110:111], v[112:113] op_sel:[1,1,0] op_sel_hi:[0,1,1] neg_lo:[1,0,0]
  v_pk_fma_f32 v[72:73], v[74:75], v[66:67], v[72:73] op_sel:[1,1,0] op_sel_hi:[0,1,1] neg_lo:[1,0,0]
  v_pk_fma_f32 v[116:117], v[118:119], v[110:111], v[116:117] op_sel:[1,1,0] op_sel_hi:[0,1,1] neg_lo:[1,0,0]
  v_pk_fma_f32 v[46:47], v[44:45], v[36:37], v[46:47] op_sel:[1,1,0] op_sel_hi:[0,1,1] neg_lo:[1,0,0]
  v_pk_fma_f32 v[90:91], v[88:89], v[80:81], v[90:91] op_sel:[1,1,0] op_sel_hi:[0,1,1] neg_lo:[1,0,0]
  v_pk_fma_f32 v[54:55], v[56:57], v[38:39], v[54:55] op_sel:[1,1,0] op_sel_hi:[0,1,1] neg_lo:[1,0,0]
  v_pk_fma_f32 v[98:99], v[100:101], v[82:83], v[98:99] op_sel:[1,1,0] op_sel_hi:[0,1,1] neg_lo:[1,0,0]
  v_pk_fma_f32 v[60:61], v[50:51], v[42:43], v[60:61] op_sel:[1,1,0] op_sel_hi:[0,1,1] neg_lo:[1,0,0]
  v_pk_fma_f32 v[104:105], v[94:95], v[86:87], v[104:105] op_sel:[1,1,0] op_sel_hi:[0,1,1] neg_lo:[1,0,0]
  v_cvt_pk_bf16_f32 v18, v68, v69
  v_cvt_pk_bf16_f32 v19, v112, v113
  ds_write_b64 v26, v[18:19] offset:16896
  v_cvt_pk_bf16_f32 v20, v72, v73
  v_cvt_pk_bf16_f32 v21, v116, v117
  ds_write_b64 v26, v[20:21] offset:17424
  v_cvt_pk_bf16_f32 v22, v46, -v47
  v_cvt_pk_bf16_f32 v23, v90, -v91
  ds_write_b64 v26, v[22:23] offset:3168
  v_cvt_pk_bf16_f32 v16, v54, -v55
  v_cvt_pk_bf16_f32 v17, v98, -v99
  ds_write_b64 v26, v[16:17] offset:6864
  v_cvt_pk_bf16_f32 v18, v60, -v61
  v_cvt_pk_bf16_f32 v19, v104, -v105
  ds_write_b64 v26, v[18:19] offset:10032
  v_pk_mul_f32 v[70:71], v[68:69], v[66:67] op_sel_hi:[1,0]
  v_pk_mul_f32 v[114:115], v[112:113], v[110:111] op_sel_hi:[1,0]
  v_pk_mul_f32 v[74:75], v[72:73], v[66:67] op_sel_hi:[1,0]
  v_pk_mul_f32 v[118:119], v[116:117], v[110:111] op_sel_hi:[1,0]
  v_pk_mul_f32 v[44:45], v[46:47], v[36:37] op_sel_hi:[1,0]
  v_pk_mul_f32 v[88:89], v[90:91], v[80:81] op_sel_hi:[1,0]
  v_pk_mul_f32 v[56:57], v[54:55], v[38:39] op_sel_hi:[1,0]
  v_pk_mul_f32 v[100:101], v[98:99], v[82:83] op_sel_hi:[1,0]
  v_pk_mul_f32 v[60:61], v[52:53], v[42:43] op_sel_hi:[1,0]
  v_pk_mul_f32 v[104:105], v[96:97], v[86:87] op_sel_hi:[1,0]
  v_pk_fma_f32 v[70:71], v[68:69], v[66:67], v[70:71] op_sel:[1,1,0] op_sel_hi:[0,1,1] neg_lo:[1,0,0]
  v_pk_fma_f32 v[114:115], v[112:113], v[110:111], v[114:115] op_sel:[1,1,0] op_sel_hi:[0,1,1] neg_lo:[1,0,0]
  v_pk_fma_f32 v[74:75], v[72:73], v[66:67], v[74:75] op_sel:[1,1,0] op_sel_hi:[0,1,1] neg_lo:[1,0,0]
  v_pk_fma_f32 v[118:119], v[116:117], v[110:111], v[118:119] op_sel:[1,1,0] op_sel_hi:[0,1,1] neg_lo:[1,0,0]
  v_pk_fma_f32 v[44:45], v[46:47], v[36:37], v[44:45] op_sel:[1,1,0] op_sel_hi:[0,1,1] neg_lo:[1,0,0]
  v_pk_fma_f32 v[88:89], v[90:91], v[80:81], v[88:89] op_sel:[1,1,0] op_sel_hi:[0,1,1] neg_lo:[1,0,0]
  v_pk_fma_f32 v[56:57], v[54:55], v[38:39], v[56:57] op_sel:[1,1,0] op_sel_hi:[0,1,1] neg_lo:[1,0,0]
  v_pk_fma_f32 v[100:101], v[98:99], v[82:83], v[100:101] op_sel:[1,1,0] op_sel_hi:[0,1,1] neg_lo:[1,0,0]
  v_pk_fma_f32 v[60:61], v[52:53], v[42:43], v[60:61] op_sel:[1,1,0] op_sel_hi:[0,1,1] neg_lo:[1,0,0]
  v_pk_fma_f32 v[104:105], v[96:97], v[86:87], v[104:105] op_sel:[1,1,0] op_sel_hi:[0,1,1] neg_lo:[1,0,0]
  v_cvt_pk_bf16_f32 v20, v70, v71
  v_cvt_pk_bf16_f32 v21, v114, v115
  ds_write_b64 v26, v[20:21] offset:17952
  v_cvt_pk_bf16_f32 v22, v74, v75
  v_cvt_pk_bf16_f32 v23, v118, v119
  ds_write_b64 v26, v[22:23] offset:18480
  v_cvt_pk_bf16_f32 v16, v44, -v45
  v_cvt_pk_bf16_f32 v17, v88, -v89
  ds_write_b64 v26, v[16:17] offset:3696
  v_cvt_pk_bf16_f32 v18, v56, -v57
  v_cvt_pk_bf16_f32 v19, v100, -v101
  ds_write_b64 v26, v[18:19] offset:7392
  v_cvt_pk_bf16_f32 v20, v60, -v61
  v_cvt_pk_bf16_f32 v21, v104, -v105
  ds_write_b64 v26, v[20:21] offset:10560
  v_pk_mul_f32 v[68:69], v[70:71], v[66:67] op_sel_hi:[1,0]
  v_pk_mul_f32 v[112:113], v[114:115], v[110:111] op_sel_hi:[1,0]
  v_pk_mul_f32 v[72:73], v[74:75], v[66:67] op_sel_hi:[1,0]
  v_pk_mul_f32 v[116:117], v[118:119], v[110:111] op_sel_hi:[1,0]
  v_pk_mul_f32 v[54:55], v[56:57], v[38:39] op_sel_hi:[1,0]
  v_pk_mul_f32 v[98:99], v[100:101], v[82:83] op_sel_hi:[1,0]
  v_pk_fma_f32 v[68:69], v[70:71], v[66:67], v[68:69] op_sel:[1,1,0] op_sel_hi:[0,1,1] neg_lo:[1,0,0]
  v_pk_fma_f32 v[112:113], v[114:115], v[110:111], v[112:113] op_sel:[1,1,0] op_sel_hi:[0,1,1] neg_lo:[1,0,0]
  v_pk_fma_f32 v[72:73], v[74:75], v[66:67], v[72:73] op_sel:[1,1,0] op_sel_hi:[0,1,1] neg_lo:[1,0,0]
  v_pk_fma_f32 v[116:117], v[118:119], v[110:111], v[116:117] op_sel:[1,1,0] op_sel_hi:[0,1,1] neg_lo:[1,0,0]
  v_pk_fma_f32 v[54:55], v[56:57], v[38:39], v[54:55] op_sel:[1,1,0] op_sel_hi:[0,1,1] neg_lo:[1,0,0]
  v_pk_fma_f32 v[98:99], v[100:101], v[82:83], v[98:99] op_sel:[1,1,0] op_sel_hi:[0,1,1] neg_lo:[1,0,0]
  v_cvt_pk_bf16_f32 v22, v68, v69
  v_cvt_pk_bf16_f32 v23, v112, v113
  ds_write_b64 v26, v[22:23] offset:19008
  v_cvt_pk_bf16_f32 v16, v72, v73
  v_cvt_pk_bf16_f32 v17, v116, v117
  ds_write_b64 v26, v[16:17] offset:19536
  v_cvt_pk_bf16_f32 v18, v54, -v55
  v_cvt_pk_bf16_f32 v19, v98, -v99
  ds_write_b64 v26, v[18:19] offset:7920
  v_pk_mul_f32 v[70:71], v[68:69], v[66:67] op_sel_hi:[1,0]
  v_pk_mul_f32 v[114:115], v[112:113], v[110:111] op_sel_hi:[1,0]
  v_pk_mul_f32 v[74:75], v[72:73], v[66:67] op_sel_hi:[1,0]
  v_pk_mul_f32 v[118:119], v[116:117], v[110:111] op_sel_hi:[1,0]
  v_pk_fma_f32 v[70:71], v[68:69], v[66:67], v[70:71] op_sel:[1,1,0] op_sel_hi:[0,1,1] neg_lo:[1,0,0]
  v_pk_fma_f32 v[114:115], v[112:113], v[110:111], v[114:115] op_sel:[1,1,0] op_sel_hi:[0,1,1] neg_lo:[1,0,0]
  v_pk_fma_f32 v[74:75], v[72:73], v[66:67], v[74:75] op_sel:[1,1,0] op_sel_hi:[0,1,1] neg_lo:[1,0,0]
  v_pk_fma_f32 v[118:119], v[116:117], v[110:111], v[118:119] op_sel:[1,1,0] op_sel_hi:[0,1,1] neg_lo:[1,0,0]
  v_cvt_pk_bf16_f32 v20, v70, v71
  v_cvt_pk_bf16_f32 v21, v114, v115
  ds_write_b64 v26, v[20:21] offset:20064
  v_cvt_pk_bf16_f32 v22, v74, v75
  v_cvt_pk_bf16_f32 v23, v118, v119
  ds_write_b64 v26, v[22:23] offset:20592
  v_pk_mul_f32 v[68:69], v[70:71], v[66:67] op_sel_hi:[1,0]
  v_pk_mul_f32 v[112:113], v[114:115], v[110:111] op_sel_hi:[1,0]
  v_pk_mul_f32 v[72:73], v[74:75], v[66:67] op_sel_hi:[1,0]
  v_pk_mul_f32 v[116:117], v[118:119], v[110:111] op_sel_hi:[1,0]
  v_pk_fma_f32 v[68:69], v[70:71], v[66:67], v[68:69] op_sel:[1,1,0] op_sel_hi:[0,1,1] neg_lo:[1,0,0]
  v_pk_fma_f32 v[112:113], v[114:115], v[110:111], v[112:113] op_sel:[1,1,0] op_sel_hi:[0,1,1] neg_lo:[1,0,0]
  v_pk_fma_f32 v[72:73], v[74:75], v[66:67], v[72:73] op_sel:[1,1,0] op_sel_hi:[0,1,1] neg_lo:[1,0,0]
  v_pk_fma_f32 v[116:117], v[118:119], v[110:111], v[116:117] op_sel:[1,1,0] op_sel_hi:[0,1,1] neg_lo:[1,0,0]
  v_cvt_pk_bf16_f32 v16, v68, v69
  v_cvt_pk_bf16_f32 v17, v112, v113
  ds_write_b64 v26, v[16:17] offset:21120
  v_cvt_pk_bf16_f32 v18, v72, v73
  v_cvt_pk_bf16_f32 v19, v116, v117
  ds_write_b64 v26, v[18:19] offset:21648
  v_pk_mul_f32 v[70:71], v[68:69], v[66:67] op_sel_hi:[1,0]
  v_pk_mul_f32 v[114:115], v[112:113], v[110:111] op_sel_hi:[1,0]
  v_pk_mul_f32 v[74:75], v[72:73], v[66:67] op_sel_hi:[1,0]
  v_pk_mul_f32 v[118:119], v[116:117], v[110:111] op_sel_hi:[1,0]
  v_pk_fma_f32 v[70:71], v[68:69], v[66:67], v[70:71] op_sel:[1,1,0] op_sel_hi:[0,1,1] neg_lo:[1,0,0]
  v_pk_fma_f32 v[114:115], v[112:113], v[110:111], v[114:115] op_sel:[1,1,0] op_sel_hi:[0,1,1] neg_lo:[1,0,0]
  v_pk_fma_f32 v[74:75], v[72:73], v[66:67], v[74:75] op_sel:[1,1,0] op_sel_hi:[0,1,1] neg_lo:[1,0,0]
  v_pk_fma_f32 v[118:119], v[116:117], v[110:111], v[118:119] op_sel:[1,1,0] op_sel_hi:[0,1,1] neg_lo:[1,0,0]
  v_cvt_pk_bf16_f32 v20, v70, v71
  v_cvt_pk_bf16_f32 v21, v114, v115
  ds_write_b64 v26, v[20:21] offset:22176
  v_cvt_pk_bf16_f32 v22, v74, v75
  v_cvt_pk_bf16_f32 v23, v118, v119
  ds_write_b64 v26, v[22:23] offset:22704
  v_pk_mul_f32 v[68:69], v[70:71], v[66:67] op_sel_hi:[1,0]
  v_pk_mul_f32 v[112:113], v[114:115], v[110:111] op_sel_hi:[1,0]
  v_pk_mul_f32 v[72:73], v[74:75], v[66:67] op_sel_hi:[1,0]
  v_pk_mul_f32 v[116:117], v[118:119], v[110:111] op_sel_hi:[1,0]
  v_pk_fma_f32 v[68:69], v[70:71], v[66:67], v[68:69] op_sel:[1,1,0] op_sel_hi:[0,1,1] neg_lo:[1,0,0]
  v_pk_fma_f32 v[112:113], v[114:115], v[110:111], v[112:113] op_sel:[1,1,0] op_sel_hi:[0,1,1] neg_lo:[1,0,0]
  v_pk_fma_f32 v[72:73], v[74:75], v[66:67], v[72:73] op_sel:[1,1,0] op_sel_hi:[0,1,1] neg_lo:[1,0,0]
  v_pk_fma_f32 v[116:117], v[118:119], v[110:111], v[116:117] op_sel:[1,1,0] op_sel_hi:[0,1,1] neg_lo:[1,0,0]
  v_cvt_pk_bf16_f32 v16, v68, v69
  v_cvt_pk_bf16_f32 v17, v112, v113
  ds_write_b64 v26, v[16:17] offset:23232
  v_cvt_pk_bf16_f32 v18, v72, v73
  v_cvt_pk_bf16_f32 v19, v116, v117
  ds_write_b64 v26, v[18:19] offset:23760
  v_pk_mul_f32 v[70:71], v[68:69], v[66:67] op_sel_hi:[1,0]
  v_pk_mul_f32 v[114:115], v[112:113], v[110:111] op_sel_hi:[1,0]
  v_pk_mul_f32 v[74:75], v[72:73], v[66:67] op_sel_hi:[1,0]
  v_pk_mul_f32 v[118:119], v[116:117], v[110:111] op_sel_hi:[1,0]
  v_pk_fma_f32 v[70:71], v[68:69], v[66:67], v[70:71] op_sel:[1,1,0] op_sel_hi:[0,1,1] neg_lo:[1,0,0]
  v_pk_fma_f32 v[114:115], v[112:113], v[110:111], v[114:115] op_sel:[1,1,0] op_sel_hi:[0,1,1] neg_lo:[1,0,0]
  v_pk_fma_f32 v[74:75], v[72:73], v[66:67], v[74:75] op_sel:[1,1,0] op_sel_hi:[0,1,1] neg_lo:[1,0,0]
  v_pk_fma_f32 v[118:119], v[116:117], v[110:111], v[118:119] op_sel:[1,1,0] op_sel_hi:[0,1,1] neg_lo:[1,0,0]
  v_cvt_pk_bf16_f32 v20, v70, v71
  v_cvt_pk_bf16_f32 v21, v114, v115
  ds_write_b64 v26, v[20:21] offset:24288
  v_cvt_pk_bf16_f32 v22, v74, v75
  v_cvt_pk_bf16_f32 v23, v118, v119
  ds_write_b64 v26, v[22:23] offset:24816
  v_pk_mul_f32 v[68:69], v[70:71], v[66:67] op_sel_hi:[1,0]
  v_pk_mul_f32 v[112:113], v[114:115], v[110:111] op_sel_hi:[1,0]
  v_pk_mul_f32 v[72:73], v[74:75], v[66:67] op_sel_hi:[1,0]
  v_pk_mul_f32 v[116:117], v[118:119], v[110:111] op_sel_hi:[1,0]
  v_pk_fma_f32 v[68:69], v[70:71], v[66:67], v[68:69] op_sel:[1,1,0] op_sel_hi:[0,1,1] neg_lo:[1,0,0]
  v_pk_fma_f32 v[112:113], v[114:115], v[110:111], v[112:113] op_sel:[1,1,0] op_sel_hi:[0,1,1] neg_lo:[1,0,0]
  v_pk_fma_f32 v[72:73], v[74:75], v[66:67], v[72:73] op_sel:[1,1,0] op_sel_hi:[0,1,1] neg_lo:[1,0,0]
  v_pk_fma_f32 v[116:117], v[118:119], v[110:111], v[116:117] op_sel:[1,1,0] op_sel_hi:[0,1,1] neg_lo:[1,0,0]
  v_cvt_pk_bf16_f32 v16, v68, v69
  v_cvt_pk_bf16_f32 v17, v112, v113
  ds_write_b64 v26, v[16:17] offset:25344
  v_cvt_pk_bf16_f32 v18, v72, v73
  v_cvt_pk_bf16_f32 v19, v116, v117
  ds_write_b64 v26, v[18:19] offset:25872
  v_pk_mul_f32 v[70:71], v[68:69], v[66:67] op_sel_hi:[1,0]
  v_pk_mul_f32 v[114:115], v[112:113], v[110:111] op_sel_hi:[1,0]
  v_pk_mul_f32 v[74:75], v[72:73], v[66:67] op_sel_hi:[1,0]
  v_pk_mul_f32 v[118:119], v[116:117], v[110:111] op_sel_hi:[1,0]
  v_pk_fma_f32 v[70:71], v[68:69], v[66:67], v[70:71] op_sel:[1,1,0] op_sel_hi:[0,1,1] neg_lo:[1,0,0]
  v_pk_fma_f32 v[114:115], v[112:113], v[110:111], v[114:115] op_sel:[1,1,0] op_sel_hi:[0,1,1] neg_lo:[1,0,0]
  v_pk_fma_f32 v[74:75], v[72:73], v[66:67], v[74:75] op_sel:[1,1,0] op_sel_hi:[0,1,1] neg_lo:[1,0,0]
  v_pk_fma_f32 v[118:119], v[116:117], v[110:111], v[118:119] op_sel:[1,1,0] op_sel_hi:[0,1,1] neg_lo:[1,0,0]
  v_cvt_pk_bf16_f32 v20, v70, v71
  v_cvt_pk_bf16_f32 v21, v114, v115
  ds_write_b64 v26, v[20:21] offset:26400
  v_cvt_pk_bf16_f32 v22, v74, v75
  v_cvt_pk_bf16_f32 v23, v118, v119
  ds_write_b64 v26, v[22:23] offset:26928
  v_pk_mul_f32 v[68:69], v[70:71], v[66:67] op_sel_hi:[1,0]
  v_pk_mul_f32 v[112:113], v[114:115], v[110:111] op_sel_hi:[1,0]
  v_pk_fma_f32 v[68:69], v[70:71], v[66:67], v[68:69] op_sel:[1,1,0] op_sel_hi:[0,1,1] neg_lo:[1,0,0]
  v_pk_fma_f32 v[112:113], v[114:115], v[110:111], v[112:113] op_sel:[1,1,0] op_sel_hi:[0,1,1] neg_lo:[1,0,0]
  v_cvt_pk_bf16_f32 v16, v68, v69
  v_cvt_pk_bf16_f32 v17, v112, v113
  ds_write_b64 v26, v[16:17] offset:27456
  v_and_b32 v27, 31, v1
  v_min_u32 v28, 20, v27
  s_movk_i32 s43, 528
  v_mul_u32_u24 v28, s43, v28
  v_mul_u32_u24 v27, s43, v27
  v_lshrrev_b32 v29, 5, v1
  v_lshlrev_b32 v29, 4, v29
  v_add3_u32 v28, v28, v29, s42
  s_add_u32 s43, s42, 11088
  v_add3_u32 v27, v27, v29, s43
  s_waitcnt lgkmcnt(0)
  ds_read_b128 v[96:99], v28 offset:0
  ds_read_b128 v[100:103], v27 offset:0
  ds_read_b128 v[104:107], v28 offset:32
  ds_read_b128 v[108:111], v27 offset:32
  ds_read_b128 v[112:115], v28 offset:64
  ds_read_b128 v[116:119], v27 offset:64
  ds_read_b128 v[120:123], v28 offset:96
  ds_read_b128 v[124:127], v27 offset:96
  ds_read_b128 v[128:131], v28 offset:128
  ds_read_b128 v[132:135], v27 offset:128
  ds_read_b128 v[136:139], v28 offset:160
  ds_read_b128 v[140:143], v27 offset:160
  v_lshrrev_b32 v29, 5, v1
  v_lshlrev_b32 v29, 9, v29
  v_and_b32 v24, 31, v1
  v_lshl_add_u32 v29, v24, 2, v29
  s_mul_i32 s42, s53, 3072
  s_add_u32 s42, s42, 111936
  v_add_u32 v29, s42, v29
  s_waitcnt lgkmcnt(10)
  v_mfma_f32_32x32x16_bf16 v[160:175], v[96:99], v[100:103], 0
  ds_read_b128 v[144:147], v28 offset:192
  ds_read_b128 v[148:151], v27 offset:192
  s_waitcnt lgkmcnt(10)
  v_mfma_f32_32x32x16_bf16 v[160:175], v[104:107], v[108:111], v[160:175]
  ds_read_b128 v[152:155], v28 offset:224
  ds_read_b128 v[156:159], v27 offset:224
  s_waitcnt lgkmcnt(10)
  v_mfma_f32_32x32x16_bf16 v[160:175], v[112:115], v[116:119], v[160:175]
  ds_read_b128 v[96:99], v28 offset:256
  ds_read_b128 v[100:103], v27 offset:256
  s_waitcnt lgkmcnt(10)
  v_mfma_f32_32x32x16_bf16 v[160:175], v[120:123], v[124:127], v[160:175]
  ds_read_b128 v[104:107], v28 offset:288
  ds_read_b128 v[108:111], v27 offset:288
  s_waitcnt lgkmcnt(10)
  v_mfma_f32_32x32x16_bf16 v[160:175], v[128:131], v[132:135], v[160:175]
  ds_read_b128 v[112:115], v28 offset:320
  ds_read_b128 v[116:119], v27 offset:320
  s_waitcnt lgkmcnt(10)
  v_mfma_f32_32x32x16_bf16 v[160:175], v[136:139], v[140:143], v[160:175]
  ds_read_b128 v[120:123], v28 offset:352
  ds_read_b128 v[124:127], v27 offset:352
  s_waitcnt lgkmcnt(10)
  v_mfma_f32_32x32x16_bf16 v[160:175], v[144:147], v[148:151], v[160:175]
  ds_read_b128 v[128:131], v28 offset:384
  ds_read_b128 v[132:135], v27 offset:384
  s_waitcnt lgkmcnt(10)
  v_mfma_f32_32x32x16_bf16 v[160:175], v[152:155], v[156:159], v[160:175]
  ds_read_b128 v[136:139], v28 offset:416
  ds_read_b128 v[140:143], v27 offset:416
  s_waitcnt lgkmcnt(10)
  v_mfma_f32_32x32x16_bf16 v[160:175], v[96:99], v[100:103], v[160:175]
  ds_read_b128 v[144:147], v28 offset:448
  ds_read_b128 v[148:151], v27 offset:448
  s_waitcnt lgkmcnt(10)
  v_mfma_f32_32x32x16_bf16 v[160:175], v[104:107], v[108:111], v[160:175]
  ds_read_b128 v[152:155], v28 offset:480
  ds_read_b128 v[156:159], v27 offset:480
  s_waitcnt lgkmcnt(10)
  v_mfma_f32_32x32x16_bf16 v[160:175], v[112:115], v[116:119], v[160:175]
  s_waitcnt lgkmcnt(8)
  v_mfma_f32_32x32x16_bf16 v[160:175], v[120:123], v[124:127], v[160:175]
  s_waitcnt lgkmcnt(6)
  v_mfma_f32_32x32x16_bf16 v[160:175], v[128:131], v[132:135], v[160:175]
  s_waitcnt lgkmcnt(4)
  v_mfma_f32_32x32x16_bf16 v[160:175], v[136:139], v[140:143], v[160:175]
  s_waitcnt lgkmcnt(2)
  v_mfma_f32_32x32x16_bf16 v[160:175], v[144:147], v[148:151], v[160:175]
  s_waitcnt lgkmcnt(0)
  v_mfma_f32_32x32x16_bf16 v[160:175], v[152:155], v[156:159], v[160:175]
  s_nop 11
  ds_write_b32 v29, v160 offset:0
  ds_write_b32 v29, v161 offset:128
  ds_write_b32 v29, v162 offset:256
  ds_write_b32 v29, v163 offset:384
  ds_write_b32 v29, v164 offset:1024
  ds_write_b32 v29, v165 offset:1152
  ds_write_b32 v29, v166 offset:1280
  ds_write_b32 v29, v167 offset:1408
  ds_write_b32 v29, v168 offset:2048
  ds_write_b32 v29, v169 offset:2176
  ds_write_b32 v29, v170 offset:2304
  ds_write_b32 v29, v171 offset:2432
  s_mul_i32 s42, s35, 6144
  s_add_u32 s42, s42, 111936
  v_lshl_add_u32 v26, v1, 2, s42
  s_lshl_b32 s54, s53, 2
  s_add_u32 s54, s54, 141632
  s_xor_b32 s55, s54, 4
  v_mov_b32 v22, s54
  v_mov_b32 v23, 1
  v_mov_b32 v21, s55
  s_waitcnt lgkmcnt(0)
  ds_write_b32 v22, v23
  s_mov_b32 s56, 0
L_kall_psa:
  ds_read_b32 v20, v21
  s_waitcnt lgkmcnt(0)
  v_readfirstlane_b32 s55, v20
  s_add_u32 s56, s56, 1
  s_cmp_lg_u32 s55, 0
  s_cbranch_scc1 L_kall_pda
  s_cmp_lt_u32 s56, 0x400000
  s_cbranch_scc1 L_kall_psa
L_kall_pda:
  s_cmp_lg_u32 s36, 0
  s_cbranch_scc1 L_kall_g1
  v_cmp_gt_u32 vcc, 32, v1
  v_mov_b32 v40, 896
  v_mov_b32 v48, 0
  v_cndmask_b32 v40, v40, v48, vcc
  v_add_u32 v40, v40, v26
  v_mov_b32 v41, 896
  v_mov_b32 v48, 128
  v_cndmask_b32 v41, v41, v48, vcc
  v_add_u32 v41, v41, v26
  v_mov_b32 v42, 1920
  v_mov_b32 v48, 256
  v_cndmask_b32 v42, v42, v48, vcc
  v_add_u32 v42, v42, v26
  v_mov_b32 v43, 2048
  v_mov_b32 v48, 384
  v_cndmask_b32 v43, v43, v48, vcc
  v_add_u32 v43, v43, v26
  v_mov_b32 v44, 2048
  v_mov_b32 v48, 512
  v_cndmask_b32 v44, v44, v48, vcc
  v_add_u32 v44, v44, v26
  v_mov_b32 v45, 2048
  v_mov_b32 v48, 640
  v_cndmask_b32 v45, v45, v48, vcc
  v_add_u32 v45, v45, v26
  v_mov_b32 v46, 2176
  v_mov_b32 v48, 768
  v_cndmask_b32 v46, v46, v48, vcc
  v_add_u32 v46, v46, v26
  v_mov_b32 v47, 900
  v_mov_b32 v48, 896
  v_cndmask_b32 v47, v47, v48, vcc
  v_add_u32 v47, v47, v26
  ds_read2st64_b32 v[48:49], v40 offset0:0 offset1:12
  ds_read2st64_b32 v[50:51], v41 offset0:0 offset1:12
  ds_read2st64_b32 v[52:53], v42 offset0:0 offset1:12
  ds_read2st64_b32 v[54:55], v43 offset0:0 offset1:12
  ds_read2st64_b32 v[56:57], v44 offset0:0 offset1:12
  ds_read2st64_b32 v[58:59], v45 offset0:0 offset1:12
  ds_read2st64_b32 v[60:61], v46 offset0:0 offset1:12
  ds_read2st64_b32 v[62:63], v47 offset0:0 offset1:12
  v_add_u32 v32, 1152, v26
  v_add_u32 v33, 2432, v26
  v_add_u32 v34, 1156, v26
  ds_read2st64_b32 v[64:65], v32 offset0:0 offset1:12
  ds_read2st64_b32 v[66:67], v33 offset0:0 offset1:12
  ds_read2st64_b32 v[68:69], v34 offset0:0 offset1:12
  s_waitcnt lgkmcnt(0)
  v_add_f32 v48, v48, v49
  v_add_f32 v50, v50, v51
  v_add_f32 v52, v52, v53
  v_add_f32 v54, v54, v55
  v_add_f32 v56, v56, v57
  v_add_f32 v58, v58, v59
  v_add_f32 v60, v60, v61
  v_add_f32 v62, v62, v63
  v_add_f32 v64, v64, v65
  v_add_f32 v66, v66, v67
  v_add_f32 v68, v68, v69
  v_cvt_pk_bf16_f32 v96, v62, v60
  v_cvt_pk_bf16_f32 v97, v58, v56
  v_cvt_pk_bf16_f32 v98, v54, v52
  v_cvt_pk_bf16_f32 v99, v50, v48
  v_cvt_pk_bf16_f32 v100, v68, v68
  v_cvt_pk_bf16_f32 v101, v66, v66
  v_cvt_pk_bf16_f32 v102, v66, v64
  v_cvt_pk_bf16_f32 v103, v64, v64
  s_branch L_kall_g2
L_kall_g1:
  v_add_u32 v40, 1408, v26
  v_add_u32 v42, 1412, v26
  v_add_u32 v41, 1664, v26
  v_add_u32 v43, 1668, v26
  ds_read2st64_b32 v[48:49], v40 offset0:0 offset1:12
  ds_read2st64_b32 v[50:51], v42 offset0:0 offset1:12
  ds_read2st64_b32 v[52:53], v41 offset0:0 offset1:12
  ds_read2st64_b32 v[54:55], v43 offset0:0 offset1:12
  v_and_b32 v44, 1, v1
  v_cmp_eq_u32 vcc, 1, v44
  v_lshrrev_b32 v45, 1, v1
  s_movk_i32 s43, 4160
  v_mul_u32_u24 v45, s43, v45
  v_lshl_add_u32 v45, v44, 4, v45
  s_mul_i32 s42, s35, 55968
  s_add_u32 s42, s42, 4096
  v_add_u32 v45, s42, v45
  v_mov_b32 v60, 0
  v_mov_b32 v61, 0
  v_mov_b32 v62, 0
  v_mov_b32 v63, 0
  s_mov_b64 s[50:51], exec
  s_mov_b64 exec, 0xff
  ds_write_b128 v45, v[60:63]
  s_mov_b64 exec, s[50:51]
  s_waitcnt lgkmcnt(0)
  v_add_f32 v48, v48, v49
  v_add_f32 v50, v50, v51
  v_cndmask_b32 v46, v48, v50, vcc
  v_cvt_pk_bf16_f32 v96, v50, v50
  v_cvt_pk_bf16_f32 v97, v50, v46
  v_cvt_pk_bf16_f32 v98, v48, v48
  v_cvt_pk_bf16_f32 v99, v48, v48
  v_add_f32 v52, v52, v53
  v_add_f32 v54, v54, v55
  v_cndmask_b32 v46, v52, v54, vcc
  v_cvt_pk_bf16_f32 v100, v54, v54
  v_cvt_pk_bf16_f32 v101, v54, v46
  v_cvt_pk_bf16_f32 v102, v52, v52
  v_cvt_pk_bf16_f32 v103, v52, v52
L_kall_g2:
  s_mul_i32 s42, s35, 55968
  s_lshl_b32 s43, s36, 11
  s_sub_u32 s42, s42, s43
  s_add_u32 s42, s42, 4080
  v_lshlrev_b32 v27, 4, v1
  v_sub_u32 v27, s42, v27
  v_subrev_u32 v28, 1024, v27
  ds_write_b128 v27, v[96:99]
  ds_write_b128 v28, v[100:103]
  s_lshl_b32 s54, s53, 2
  s_add_u32 s54, s54, 141648
  s_xor_b32 s55, s54, 4
  v_mov_b32 v22, s54
  v_mov_b32 v23, 1
  v_mov_b32 v21, s55
  s_waitcnt lgkmcnt(0)
  ds_write_b32 v22, v23
  s_mov_b32 s56, 0
L_kall_psb:
  ds_read_b32 v20, v21
  s_waitcnt lgkmcnt(0)
  v_readfirstlane_b32 s55, v20
  s_add_u32 s56, s56, 1
  s_cmp_lg_u32 s55, 0
  s_cbranch_scc1 L_kall_pdb
  s_cmp_lt_u32 s56, 0x400000
  s_cbranch_scc1 L_kall_psb
L_kall_pdb:
  ds_read_b64 v[104:105], v27 offset:16
  ds_read_b64 v[108:109], v28 offset:16
  v_and_b32 v36, 3, v1
  v_bfe_u32 v35, v1, 2, 1
  v_bfe_u32 v37, v1, 3, 1
  v_lshrrev_b32 v38, 4, v1
  v_sub_u32 v36, 3, v36
  s_movk_i32 s43, 4160
  v_mul_u32_u24 v36, s43, v36
  v_sub_u32 v39, v38, v37
  v_lshl_add_u32 v36, v39, 4, v36
  v_sub_u32 v35, 1, v35
  v_lshl_add_u32 v36, v35, 3, v36
  s_mul_i32 s42, s35, 55968
  s_add_u32 s42, s42, 464
  s_lshl_b32 s43, s36, 8
  s_sub_u32 s42, s42, s43
  v_add_u32 v24, s42, v36
  v_and_b32 v36, 15, v1
  v_lshlrev_b32 v36, 5, v36
  v_lshl_add_u32 v36, v38, 4, v36
  s_mul_i32 s42, s35, 4608
  s_add_u32 s42, s42, 124704
  s_sub_u32 s42, s42, s43
  v_add_u32 v25, s42, v36
  s_waitcnt lgkmcnt(1)
  v_alignbit_b32 v112, v97, v96, 16
  v_alignbit_b32 v113, v98, v97, 16
  v_alignbit_b32 v114, v99, v98, 16
  v_alignbit_b32 v115, v104, v99, 16
  v_mov_b32 v118, v97
  v_mov_b32 v119, v98
  v_mov_b32 v120, v99
  v_mov_b32 v121, v104
  v_alignbit_b32 v122, v98, v97, 16
  v_alignbit_b32 v123, v99, v98, 16
  v_alignbit_b32 v124, v104, v99, 16
  v_alignbit_b32 v125, v105, v104, 16
  ds_write_b128 v27, v[112:115] offset:4160
  ds_write_b128 v27, v[118:121] offset:8320
  ds_write_b128 v27, v[122:125] offset:12480
  s_waitcnt lgkmcnt(0)
  v_alignbit_b32 v128, v101, v100, 16
  v_alignbit_b32 v129, v102, v101, 16
  v_alignbit_b32 v130, v103, v102, 16
  v_alignbit_b32 v131, v108, v103, 16
  v_mov_b32 v134, v101
  v_mov_b32 v135, v102
  v_mov_b32 v136, v103
  v_mov_b32 v137, v108
  v_alignbit_b32 v138, v102, v101, 16
  v_alignbit_b32 v139, v103, v102, 16
  v_alignbit_b32 v140, v108, v103, 16
  v_alignbit_b32 v141, v109, v108, 16
  ds_write_b128 v28, v[128:131] offset:4160
  ds_write_b128 v28, v[134:137] offset:8320
  ds_write_b128 v28, v[138:141] offset:12480
  v_and_b32 v37, 15, v1
  v_lshlrev_b32 v37, 5, v37
  v_lshrrev_b32 v38, 4, v1
  v_lshl_add_u32 v37, v38, 3, v37
  s_lshl_b32 s44, s36, 2
  s_add_u32 s44, s44, 0
  s_lshl_b32 s44, s44, 9
  v_add_u32 v37, s44, v37
  s_mul_i32 s42, s35, 4608
  s_add_u32 s42, s42, 124736
  v_add_u32 v32, s42, v37
  s_lshl_b32 s42, s35, 12
  s_add_u32 s42, s42, 133440
  v_add_u32 v33, s42, v37
  s_lshl_b32 s42, s37, 12
  s_add_u32 s42, s42, 65536
  v_add_u32 v35, s42, v37
  v_mov_b32 v36, s41
  s_waitcnt lgkmcnt(0)
  s_barrier
  ds_read_b64 v[48:49], v32
  ds_read_b64 v[50:51], v32 offset:512
  ds_read_b64 v[52:53], v33
  ds_read_b64 v[54:55], v33 offset:512
  ds_read_b64 v[64:65], v24 offset:3584
  ds_read_b64 v[66:67], v24 offset:3592
  ds_read_b128 v[96:99], v25 offset:0
  ds_read_b64 v[68:69], v24 offset:3072
  ds_read_b64 v[70:71], v24 offset:3080
  ds_read_b128 v[100:103], v25 offset:512
  ds_read_b64 v[72:73], v24 offset:2560
  ds_read_b64 v[74:75], v24 offset:2568
  ds_read_b128 v[104:107], v25 offset:1024
  ds_read_b64 v[76:77], v24 offset:2048
  ds_read_b64 v[78:79], v24 offset:2056
  ds_read_b128 v[108:111], v25 offset:1536
  ds_read_b64 v[80:81], v24 offset:1536
  ds_read_b64 v[82:83], v24 offset:1544
  ds_read_b128 v[112:115], v25 offset:2048
  ds_read_b64 v[84:85], v24 offset:1024
  ds_read_b64 v[86:87], v24 offset:1032
  ds_read_b128 v[116:119], v25 offset:2560
  ds_read_b64 v[88:89], v24 offset:512
  ds_read_b64 v[90:91], v24 offset:520
  ds_read_b128 v[120:123], v25 offset:3072
  ds_read_b64 v[92:93], v24 offset:0
  ds_read_b64 v[94:95], v24 offset:8
  ds_read_b128 v[124:127], v25 offset:3584
  v_subrev_u32 v28, 64, v24
  v_subrev_u32 v29, 64, v25
  s_waitcnt lgkmcnt(15)
  v_mfma_f32_16x16x32_bf16 v[192:195], v[64:67], v[96:99], 0
  s_waitcnt lgkmcnt(15)
  v_mfma_f32_16x16x32_bf16 v[196:199], v[68:71], v[96:99], 0
  v_mfma_f32_16x16x32_bf16 v[196:199], v[64:67], v[100:103], v[196:199]
  v_mfma_f32_16x16x32_bf16 v[200:203], v[68:71], v[100:103], 0
  s_waitcnt lgkmcnt(15)
  v_mfma_f32_16x16x32_bf16 v[200:203], v[72:75], v[96:99], v[200:203]
  v_mfma_f32_16x16x32_bf16 v[200:203], v[64:67], v[104:107], v[200:203]
  v_mfma_f32_16x16x32_bf16 v[204:207], v[72:75], v[100:103], 0
  v_mfma_f32_16x16x32_bf16 v[204:207], v[68:71], v[104:107], v[204:207]
  v_mfma_f32_16x16x32_bf16 v[208:211], v[72:75], v[104:107], 0
  s_waitcnt lgkmcnt(0)
  v_mfma_f32_16x16x32_bf16 v[204:207], v[76:79], v[96:99], v[204:207]
  v_mfma_f32_16x16x32_bf16 v[204:207], v[64:67], v[108:111], v[204:207]
  v_mfma_f32_16x16x32_bf16 v[208:211], v[76:79], v[100:103], v[208:211]
  v_mfma_f32_16x16x32_bf16 v[208:211], v[68:71], v[108:111], v[208:211]
  ds_read_b64 v[128:129], v28 offset:3584
  v_mfma_f32_16x16x32_bf16 v[212:215], v[76:79], v[104:107], 0
  ds_read_b64 v[130:131], v28 offset:3592
  v_mfma_f32_16x16x32_bf16 v[212:215], v[72:75], v[108:111], v[212:215]
  ds_read_b128 v[160:163], v29 offset:0
  v_mfma_f32_16x16x32_bf16 v[216:219], v[76:79], v[108:111], 0
  ds_read_b64 v[132:133], v28 offset:3072
  v_mfma_f32_16x16x32_bf16 v[208:211], v[80:83], v[96:99], v[208:211]
  ds_read_b64 v[134:135], v28 offset:3080
  v_mfma_f32_16x16x32_bf16 v[208:211], v[64:67], v[112:115], v[208:211]
  ds_read_b128 v[164:167], v29 offset:512
  v_mfma_f32_16x16x32_bf16 v[212:215], v[80:83], v[100:103], v[212:215]
  ds_read_b64 v[136:137], v28 offset:2560
  v_mfma_f32_16x16x32_bf16 v[212:215], v[68:71], v[112:115], v[212:215]
  ds_read_b64 v[138:139], v28 offset:2568
  v_mfma_f32_16x16x32_bf16 v[216:219], v[80:83], v[104:107], v[216:219]
  ds_read_b128 v[168:171], v29 offset:1024
  v_mfma_f32_16x16x32_bf16 v[216:219], v[72:75], v[112:115], v[216:219]
  ds_read_b64 v[140:141], v28 offset:2048
  v_mfma_f32_16x16x32_bf16 v[220:223], v[80:83], v[108:111], 0
  ds_read_b64 v[142:143], v28 offset:2056
  v_mfma_f32_16x16x32_bf16 v[220:223], v[76:79], v[112:115], v[220:223]
  ds_read_b128 v[172:175], v29 offset:1536
  v_mfma_f32_16x16x32_bf16 v[212:215], v[84:87], v[96:99], v[212:215]
  ds_read_b64 v[144:145], v28 offset:1536
  v_mfma_f32_16x16x32_bf16 v[212:215], v[64:67], v[116:119], v[212:215]
  ds_read_b64 v[146:147], v28 offset:1544
  v_mfma_f32_16x16x32_bf16 v[216:219], v[84:87], v[100:103], v[216:219]
  ds_read_b128 v[176:179], v29 offset:2048
  v_mfma_f32_16x16x32_bf16 v[216:219], v[68:71], v[116:119], v[216:219]
  ds_read_b64 v[148:149], v28 offset:1024
  v_mfma_f32_16x16x32_bf16 v[220:223], v[84:87], v[104:107], v[220:223]
  ds_read_b64 v[150:151], v28 offset:1032
  v_mfma_f32_16x16x32_bf16 v[220:223], v[72:75], v[116:119], v[220:223]
  ds_read_b128 v[180:183], v29 offset:2560
  v_mfma_f32_16x16x32_bf16 v[216:219], v[88:91], v[96:99], v[216:219]
  ds_read_b64 v[152:153], v28 offset:512
  v_mfma_f32_16x16x32_bf16 v[216:219], v[64:67], v[120:123], v[216:219]
  ds_read_b64 v[154:155], v28 offset:520
  v_mfma_f32_16x16x32_bf16 v[220:223], v[88:91], v[100:103], v[220:223]
  ds_read_b128 v[184:187], v29 offset:3072
  v_mfma_f32_16x16x32_bf16 v[220:223], v[68:71], v[120:123], v[220:223]
  ds_read_b64 v[156:157], v28 offset:0
  v_mfma_f32_16x16x32_bf16 v[220:223], v[92:95], v[96:99], v[220:223]
  ds_read_b64 v[158:159], v28 offset:8
  v_mfma_f32_16x16x32_bf16 v[220:223], v[64:67], v[124:127], v[220:223]
  ds_read_b128 v[188:191], v29 offset:3584
  v_subrev_u32 v30, 128, v24
  v_subrev_u32 v31, 128, v25
  s_waitcnt lgkmcnt(0)
  v_mfma_f32_16x16x32_bf16 v[192:195], v[128:131], v[160:163], v[192:195]
  v_mfma_f32_16x16x32_bf16 v[196:199], v[132:135], v[160:163], v[196:199]
  ds_read_b64 v[64:65], v30 offset:3584
  v_mfma_f32_16x16x32_bf16 v[196:199], v[128:131], v[164:167], v[196:199]
  ds_read_b64 v[66:67], v30 offset:3592
  v_mfma_f32_16x16x32_bf16 v[200:203], v[132:135], v[164:167], v[200:203]
  ds_read_b128 v[96:99], v31 offset:0
  v_mfma_f32_16x16x32_bf16 v[200:203], v[136:139], v[160:163], v[200:203]
  ds_read_b64 v[68:69], v30 offset:3072
  v_mfma_f32_16x16x32_bf16 v[200:203], v[128:131], v[168:171], v[200:203]
  ds_read_b64 v[70:71], v30 offset:3080
  v_mfma_f32_16x16x32_bf16 v[204:207], v[136:139], v[164:167], v[204:207]
  ds_read_b128 v[100:103], v31 offset:512
  v_mfma_f32_16x16x32_bf16 v[204:207], v[132:135], v[168:171], v[204:207]
  ds_read_b64 v[72:73], v30 offset:2560
  v_mfma_f32_16x16x32_bf16 v[208:211], v[136:139], v[168:171], v[208:211]
  ds_read_b64 v[74:75], v30 offset:2568
  v_mfma_f32_16x16x32_bf16 v[204:207], v[140:143], v[160:163], v[204:207]
  ds_read_b128 v[104:107], v31 offset:1024
  v_mfma_f32_16x16x32_bf16 v[204:207], v[128:131], v[172:175], v[204:207]
  ds_read_b64 v[76:77], v30 offset:2048
  v_mfma_f32_16x16x32_bf16 v[208:211], v[140:143], v[164:167], v[208:211]
  ds_read_b64 v[78:79], v30 offset:2056
  v_mfma_f32_16x16x32_bf16 v[208:211], v[132:135], v[172:175], v[208:211]
  ds_read_b128 v[108:111], v31 offset:1536
  v_mfma_f32_16x16x32_bf16 v[212:215], v[140:143], v[168:171], v[212:215]
  ds_read_b64 v[80:81], v30 offset:1536
  v_mfma_f32_16x16x32_bf16 v[212:215], v[136:139], v[172:175], v[212:215]
  ds_read_b64 v[82:83], v30 offset:1544
  v_mfma_f32_16x16x32_bf16 v[216:219], v[140:143], v[172:175], v[216:219]
  ds_read_b128 v[112:115], v31 offset:2048
  v_mfma_f32_16x16x32_bf16 v[208:211], v[144:147], v[160:163], v[208:211]
  ds_read_b64 v[84:85], v30 offset:1024
  v_mfma_f32_16x16x32_bf16 v[208:211], v[128:131], v[176:179], v[208:211]
  ds_read_b64 v[86:87], v30 offset:1032
  v_mfma_f32_16x16x32_bf16 v[212:215], v[144:147], v[164:167], v[212:215]
  ds_read_b128 v[116:119], v31 offset:2560
  v_mfma_f32_16x16x32_bf16 v[212:215], v[132:135], v[176:179], v[212:215]
  ds_read_b64 v[88:89], v30 offset:512
  v_mfma_f32_16x16x32_bf16 v[216:219], v[144:147], v[168:171], v[216:219]
  ds_read_b64 v[90:91], v30 offset:520
  v_mfma_f32_16x16x32_bf16 v[216:219], v[136:139], v[176:179], v[216:219]
  ds_read_b128 v[120:123], v31 offset:3072
  v_mfma_f32_16x16x32_bf16 v[220:223], v[144:147], v[172:175], v[220:223]
  ds_read_b64 v[92:93], v30 offset:0
  v_mfma_f32_16x16x32_bf16 v[220:223], v[140:143], v[176:179], v[220:223]
  ds_read_b64 v[94:95], v30 offset:8
  v_mfma_f32_16x16x32_bf16 v[212:215], v[148:151], v[160:163], v[212:215]
  ds_read_b128 v[124:127], v31 offset:3584
  v_mfma_f32_16x16x32_bf16 v[212:215], v[128:131], v[180:183], v[212:215]
  v_mfma_f32_16x16x32_bf16 v[216:219], v[148:151], v[164:167], v[216:219]
  v_mfma_f32_16x16x32_bf16 v[216:219], v[132:135], v[180:183], v[216:219]
  v_mfma_f32_16x16x32_bf16 v[220:223], v[148:151], v[168:171], v[220:223]
  v_mfma_f32_16x16x32_bf16 v[220:223], v[136:139], v[180:183], v[220:223]
  v_mfma_f32_16x16x32_bf16 v[216:219], v[152:155], v[160:163], v[216:219]
  v_mfma_f32_16x16x32_bf16 v[216:219], v[128:131], v[184:187], v[216:219]
  v_mfma_f32_16x16x32_bf16 v[220:223], v[152:155], v[164:167], v[220:223]
  v_mfma_f32_16x16x32_bf16 v[220:223], v[132:135], v[184:187], v[220:223]
  v_mfma_f32_16x16x32_bf16 v[220:223], v[156:159], v[160:163], v[220:223]
  v_mfma_f32_16x16x32_bf16 v[220:223], v[128:131], v[188:191], v[220:223]
  v_subrev_u32 v28, 192, v24
  v_subrev_u32 v29, 192, v25
  s_waitcnt lgkmcnt(0)
  v_mfma_f32_16x16x32_bf16 v[192:195], v[64:67], v[96:99], v[192:195]
  v_mfma_f32_16x16x32_bf16 v[196:199], v[68:71], v[96:99], v[196:199]
  ds_read_b64 v[128:129], v28 offset:3584
  v_mfma_f32_16x16x32_bf16 v[196:199], v[64:67], v[100:103], v[196:199]
  ds_read_b64 v[130:131], v28 offset:3592
  v_mfma_f32_16x16x32_bf16 v[200:203], v[68:71], v[100:103], v[200:203]
  ds_read_b128 v[160:163], v29 offset:0
  v_mfma_f32_16x16x32_bf16 v[200:203], v[72:75], v[96:99], v[200:203]
  ds_read_b64 v[132:133], v28 offset:3072
  v_mfma_f32_16x16x32_bf16 v[200:203], v[64:67], v[104:107], v[200:203]
  ds_read_b64 v[134:135], v28 offset:3080
  v_mfma_f32_16x16x32_bf16 v[204:207], v[72:75], v[100:103], v[204:207]
  ds_read_b128 v[164:167], v29 offset:512
  v_mfma_f32_16x16x32_bf16 v[204:207], v[68:71], v[104:107], v[204:207]
  ds_read_b64 v[136:137], v28 offset:2560
  v_mfma_f32_16x16x32_bf16 v[208:211], v[72:75], v[104:107], v[208:211]
  ds_read_b64 v[138:139], v28 offset:2568
  v_mfma_f32_16x16x32_bf16 v[204:207], v[76:79], v[96:99], v[204:207]
  ds_read_b128 v[168:171], v29 offset:1024
  v_mfma_f32_16x16x32_bf16 v[204:207], v[64:67], v[108:111], v[204:207]
  ds_read_b64 v[140:141], v28 offset:2048
  v_mfma_f32_16x16x32_bf16 v[208:211], v[76:79], v[100:103], v[208:211]
  ds_read_b64 v[142:143], v28 offset:2056
  v_mfma_f32_16x16x32_bf16 v[208:211], v[68:71], v[108:111], v[208:211]
  ds_read_b128 v[172:175], v29 offset:1536
  v_mfma_f32_16x16x32_bf16 v[212:215], v[76:79], v[104:107], v[212:215]
  ds_read_b64 v[144:145], v28 offset:1536
  v_mfma_f32_16x16x32_bf16 v[212:215], v[72:75], v[108:111], v[212:215]
  ds_read_b64 v[146:147], v28 offset:1544
  v_mfma_f32_16x16x32_bf16 v[216:219], v[76:79], v[108:111], v[216:219]
  ds_read_b128 v[176:179], v29 offset:2048
  v_mfma_f32_16x16x32_bf16 v[208:211], v[80:83], v[96:99], v[208:211]
  ds_read_b64 v[148:149], v28 offset:1024
  v_mfma_f32_16x16x32_bf16 v[208:211], v[64:67], v[112:115], v[208:211]
  ds_read_b64 v[150:151], v28 offset:1032
  v_mfma_f32_16x16x32_bf16 v[212:215], v[80:83], v[100:103], v[212:215]
  ds_read_b128 v[180:183], v29 offset:2560
  v_mfma_f32_16x16x32_bf16 v[212:215], v[68:71], v[112:115], v[212:215]
  ds_read_b64 v[152:153], v28 offset:512
  v_mfma_f32_16x16x32_bf16 v[216:219], v[80:83], v[104:107], v[216:219]
  ds_read_b64 v[154:155], v28 offset:520
  v_mfma_f32_16x16x32_bf16 v[216:219], v[72:75], v[112:115], v[216:219]
  ds_read_b128 v[184:187], v29 offset:3072
  v_mfma_f32_16x16x32_bf16 v[220:223], v[80:83], v[108:111], v[220:223]
  ds_read_b64 v[156:157], v28 offset:0
  v_mfma_f32_16x16x32_bf16 v[220:223], v[76:79], v[112:115], v[220:223]
  ds_read_b64 v[158:159], v28 offset:8
  v_mfma_f32_16x16x32_bf16 v[212:215], v[84:87], v[96:99], v[212:215]
  ds_read_b128 v[188:191], v29 offset:3584
  v_mfma_f32_16x16x32_bf16 v[212:215], v[64:67], v[116:119], v[212:215]
  v_mfma_f32_16x16x32_bf16 v[216:219], v[84:87], v[100:103], v[216:219]
  v_mfma_f32_16x16x32_bf16 v[216:219], v[68:71], v[116:119], v[216:219]
  v_mfma_f32_16x16x32_bf16 v[220:223], v[84:87], v[104:107], v[220:223]
  v_mfma_f32_16x16x32_bf16 v[220:223], v[72:75], v[116:119], v[220:223]
  v_mfma_f32_16x16x32_bf16 v[216:219], v[88:91], v[96:99], v[216:219]
  v_mfma_f32_16x16x32_bf16 v[216:219], v[64:67], v[120:123], v[216:219]
  v_mfma_f32_16x16x32_bf16 v[220:223], v[88:91], v[100:103], v[220:223]
  v_mfma_f32_16x16x32_bf16 v[220:223], v[68:71], v[120:123], v[220:223]
  v_mfma_f32_16x16x32_bf16 v[220:223], v[92:95], v[96:99], v[220:223]
  v_mfma_f32_16x16x32_bf16 v[220:223], v[64:67], v[124:127], v[220:223]
  s_waitcnt lgkmcnt(0)
  v_mfma_f32_16x16x32_bf16 v[192:195], v[128:131], v[160:163], v[192:195]
  v_mfma_f32_16x16x32_bf16 v[196:199], v[132:135], v[160:163], v[196:199]
  v_mfma_f32_16x16x32_bf16 v[196:199], v[128:131], v[164:167], v[196:199]
  v_mfma_f32_16x16x32_bf16 v[200:203], v[132:135], v[164:167], v[200:203]
  v_mfma_f32_16x16x32_bf16 v[200:203], v[136:139], v[160:163], v[200:203]
  v_mfma_f32_16x16x32_bf16 v[200:203], v[128:131], v[168:171], v[200:203]
  v_mfma_f32_16x16x32_bf16 v[204:207], v[136:139], v[164:167], v[204:207]
  v_mfma_f32_16x16x32_bf16 v[204:207], v[132:135], v[168:171], v[204:207]
  v_mfma_f32_16x16x32_bf16 v[208:211], v[136:139], v[168:171], v[208:211]
  v_mfma_f32_16x16x32_bf16 v[204:207], v[140:143], v[160:163], v[204:207]
  v_mfma_f32_16x16x32_bf16 v[204:207], v[128:131], v[172:175], v[204:207]
  v_mfma_f32_16x16x32_bf16 v[208:211], v[140:143], v[164:167], v[208:211]
  v_mfma_f32_16x16x32_bf16 v[208:211], v[132:135], v[172:175], v[208:211]
  v_mfma_f32_16x16x32_bf16 v[212:215], v[140:143], v[168:171], v[212:215]
  v_mfma_f32_16x16x32_bf16 v[212:215], v[136:139], v[172:175], v[212:215]
  v_mfma_f32_16x16x32_bf16 v[216:219], v[140:143], v[172:175], v[216:219]
  v_mfma_f32_16x16x32_bf16 v[208:211], v[144:147], v[160:163], v[208:211]
  v_mfma_f32_16x16x32_bf16 v[208:211], v[128:131], v[176:179], v[208:211]
  v_mfma_f32_16x16x32_bf16 v[212:215], v[144:147], v[164:167], v[212:215]
  v_mfma_f32_16x16x32_bf16 v[212:215], v[132:135], v[176:179], v[212:215]
  v_mfma_f32_16x16x32_bf16 v[216:219], v[144:147], v[168:171], v[216:219]
  v_mfma_f32_16x16x32_bf16 v[216:219], v[136:139], v[176:179], v[216:219]
  v_mfma_f32_16x16x32_bf16 v[220:223], v[144:147], v[172:175], v[220:223]
  v_mfma_f32_16x16x32_bf16 v[220:223], v[140:143], v[176:179], v[220:223]
  v_mfma_f32_16x16x32_bf16 v[212:215], v[148:151], v[160:163], v[212:215]
  v_mfma_f32_16x16x32_bf16 v[212:215], v[128:131], v[180:183], v[212:215]
  v_mfma_f32_16x16x32_bf16 v[216:219], v[148:151], v[164:167], v[216:219]
  v_mfma_f32_16x16x32_bf16 v[216:219], v[132:135], v[180:183], v[216:219]
  v_mfma_f32_16x16x32_bf16 v[220:223], v[148:151], v[168:171], v[220:223]
  v_mfma_f32_16x16x32_bf16 v[220:223], v[136:139], v[180:183], v[220:223]
  v_mfma_f32_16x16x32_bf16 v[216:219], v[152:155], v[160:163], v[216:219]
  v_mfma_f32_16x16x32_bf16 v[216:219], v[128:131], v[184:187], v[216:219]
  v_mfma_f32_16x16x32_bf16 v[220:223], v[152:155], v[164:167], v[220:223]
  v_mfma_f32_16x16x32_bf16 v[220:223], v[132:135], v[184:187], v[220:223]
  v_mfma_f32_16x16x32_bf16 v[220:223], v[156:159], v[160:163], v[220:223]
  v_mfma_f32_16x16x32_bf16 v[220:223], v[128:131], v[188:191], v[220:223]
  v_lshlrev_b32 v56, 16, v48
  v_and_b32 v57, s46, v48
  v_lshlrev_b32 v58, 16, v49
  v_and_b32 v59, s46, v49
  v_lshlrev_b32 v40, 16, v52
  v_and_b32 v41, s46, v52
  v_lshlrev_b32 v42, 16, v53
  v_and_b32 v43, s46, v53
  v_pk_fma_f32 v[40:41], v[56:57], v[36:37], v[40:41] op_sel_hi:[1,0,1]
  v_pk_fma_f32 v[42:43], v[58:59], v[36:37], v[42:43] op_sel_hi:[1,0,1]
  v_lshlrev_b32 v56, 16, v50
  v_and_b32 v57, s46, v50
  v_lshlrev_b32 v58, 16, v51
  v_and_b32 v59, s46, v51
  v_lshlrev_b32 v44, 16, v54
  v_and_b32 v45, s46, v54
  v_lshlrev_b32 v46, 16, v55
  v_and_b32 v47, s46, v55
  v_pk_fma_f32 v[44:45], v[56:57], v[36:37], v[44:45] op_sel_hi:[1,0,1]
  v_pk_fma_f32 v[46:47], v[58:59], v[36:37], v[46:47] op_sel_hi:[1,0,1]
  s_lshl_b32 s42, s53, 13
  s_add_u32 s42, s42, 16640
  v_lshl_add_u32 v28, v1, 4, s42
  s_cmp_lg_u32 s36, 0
  s_cbranch_scc1 L_kall_x1
  ds_write_b128 v28, v[200:203] offset:2048
  ds_write_b128 v28, v[204:207] offset:3072
  ds_write_b128 v28, v[208:211] offset:4096
  ds_write_b128 v28, v[212:215] offset:5120
  ds_write_b128 v28, v[216:219] offset:6144
  ds_write_b128 v28, v[220:223] offset:7168
  v_mov_b32 v64, v192
  v_mov_b32 v65, v193
  v_mov_b32 v66, v194
  v_mov_b32 v67, v195
  v_mov_b32 v68, v196
  v_mov_b32 v69, v197
  v_mov_b32 v70, v198
  v_mov_b32 v71, v199
  s_branch L_kall_x2
L_kall_x1:
  ds_write_b128 v28, v[192:195] offset:0
  ds_write_b128 v28, v[196:199] offset:1024
  ds_write_b128 v28, v[200:203] offset:2048
  ds_write_b128 v28, v[204:207] offset:3072
  ds_write_b128 v28, v[216:219] offset:6144
  ds_write_b128 v28, v[220:223] offset:7168
  v_mov_b32 v64, v208
  v_mov_b32 v65, v209
  v_mov_b32 v66, v210
  v_mov_b32 v67, v211
  v_mov_b32 v68, v212
  v_mov_b32 v69, v213
  v_mov_b32 v70, v214
  v_mov_b32 v71, v215
L_kall_x2:
  s_xor_b32 s42, s53, 1
  s_lshl_b32 s42, s42, 13
  s_lshl_b32 s43, s36, 12
  s_add_u32 s42, s42, s43
  s_add_u32 s42, s42, 16640
  v_lshl_add_u32 v29, v1, 4, s42
  s_waitcnt lgkmcnt(0)
  s_barrier
  ds_read_b128 v[72:75], v29
  ds_read_b128 v[76:79], v29 offset:1024
  s_waitcnt lgkmcnt(0)
  v_pk_add_f32 v[64:65], v[64:65], v[72:73]
  v_pk_add_f32 v[66:67], v[66:67], v[74:75]
  v_pk_add_f32 v[68:69], v[68:69], v[76:77]
  v_pk_add_f32 v[70:71], v[70:71], v[78:79]
  s_branch L_kall_fin
L_kall_V:
  v_mov_b32 v26, 59392
  global_load_dword v28, v26, s[26:27]
  v_mov_b32 v27, 192
  global_load_dword v29, v27, s[24:25]
  global_load_dword v2, v25, s[4:5] offset:-3584
  global_load_dword v3, v25, s[4:5] offset:-2688
  global_load_dword v4, v25, s[4:5] offset:-1792
  global_load_dword v5, v25, s[4:5] offset:-896
  global_load_dword v6, v25, s[4:5] offset:0
  global_load_dword v7, v25, s[4:5] offset:896
  global_load_dword v8, v25, s[4:5] offset:1792
  global_load_dword v9, v25, s[4:5] offset:2688
  v_mov_b32 v31, 0
  s_mov_b32 s47, 0
  v_mov_b32 v26, 141664
  v_and_b32 v25, 255, v0
  v_lshlrev_b32 v25, 6, v25
  v_add_u32 v25, 0, v25
  v_and_b32 v24, 255, v0
  v_lshlrev_b32 v24, 4, v24
  v_add_u32 v24, 124736, v24
  s_waitcnt vmcnt(0)
  s_cmp_lg_u32 s33, 4
  s_cbranch_scc1 L_kall_lpoll
L_kall_poll:
  global_load_dword v27, v31, s[24:25] offset:0 sc1
  s_waitcnt vmcnt(0)
  v_readfirstlane_b32 s48, v27
  s_add_u32 s47, s47, 1
  s_cmp_ge_u32 s48, 32
  s_cbranch_scc1 L_kall_seen
  s_cmp_ge_u32 s47, 0x40000
  s_cbranch_scc1 L_kall_seen
  s_sleep 2
  s_branch L_kall_poll
L_kall_seen:
  v_mov_b32 v27, 1
  ds_write_b32 v26, v27
  s_branch L_kall_go
L_kall_lpoll:
  ds_read_b32 v27, v26
  s_waitcnt lgkmcnt(0)
  v_readfirstlane_b32 s48, v27
  s_add_u32 s47, s47, 1
  s_cmp_lg_u32 s48, 0
  s_cbranch_scc1 L_kall_go
  s_cmp_ge_u32 s47, 0x400000
  s_cbranch_scc1 L_kall_go
  s_sleep 1
  s_branch L_kall_lpoll
L_kall_go:
  global_load_dwordx4 v[32:35], v25, s[26:27] sc1
  global_load_dwordx4 v[36:39], v25, s[26:27] offset:16 sc1
  global_load_dwordx4 v[40:43], v25, s[26:27] offset:32 sc1
  global_load_dwordx4 v[44:47], v25, s[26:27] offset:48 sc1
  s_mov_b32 s48, 0x05040100
  s_mov_b32 s49, 0x07060302
  v_perm_b32 v72, v3, v2, s48
  v_perm_b32 v76, v3, v2, s49
  v_perm_b32 v73, v5, v4, s48
  v_perm_b32 v77, v5, v4, s49
  v_perm_b32 v74, v7, v6, s48
  v_perm_b32 v78, v7, v6, s49
  v_perm_b32 v75, v9, v8, s48
  v_perm_b32 v79, v9, v8, s49
  ds_write_b128 v24, v[72:75] offset:8704
  ds_write_b128 v24, v[76:79] offset:12800
  v_lshlrev_b32 v48, 16, v2
  v_and_b32 v49, s46, v2
  v_lshlrev_b32 v50, 16, v3
  v_and_b32 v51, s46, v3
  v_lshlrev_b32 v52, 16, v4
  v_and_b32 v53, s46, v4
  v_lshlrev_b32 v54, 16, v5
  v_and_b32 v55, s46, v5
  v_lshlrev_b32 v56, 16, v6
  v_and_b32 v57, s46, v6
  v_lshlrev_b32 v58, 16, v7
  v_and_b32 v59, s46, v7
  v_lshlrev_b32 v60, 16, v8
  v_and_b32 v61, s46, v8
  v_lshlrev_b32 v62, 16, v9
  v_and_b32 v63, s46, v9
  s_waitcnt vmcnt(0)
  v_pk_add_f32 v[48:49], v[48:49], v[32:33] op_sel_hi:[1,0] neg_lo:[0,1] neg_hi:[0,1]
  v_pk_add_f32 v[50:51], v[50:51], v[34:35] op_sel_hi:[1,0] neg_lo:[0,1] neg_hi:[0,1]
  v_pk_add_f32 v[52:53], v[52:53], v[36:37] op_sel_hi:[1,0] neg_lo:[0,1] neg_hi:[0,1]
  v_pk_add_f32 v[54:55], v[54:55], v[38:39] op_sel_hi:[1,0] neg_lo:[0,1] neg_hi:[0,1]
  v_pk_add_f32 v[56:57], v[56:57], v[40:41] op_sel_hi:[1,0] neg_lo:[0,1] neg_hi:[0,1]
  v_pk_add_f32 v[58:59], v[58:59], v[42:43] op_sel_hi:[1,0] neg_lo:[0,1] neg_hi:[0,1]
  v_pk_add_f32 v[60:61], v[60:61], v[44:45] op_sel_hi:[1,0] neg_lo:[0,1] neg_hi:[0,1]
  v_pk_add_f32 v[62:63], v[62:63], v[46:47] op_sel_hi:[1,0] neg_lo:[0,1] neg_hi:[0,1]
  v_cvt_pk_bf16_f32 v2, v48, v49
  v_cvt_pk_bf16_f32 v3, v50, v51
  v_cvt_pk_bf16_f32 v4, v52, v53
  v_cvt_pk_bf16_f32 v5, v54, v55
  v_cvt_pk_bf16_f32 v6, v56, v57
  v_cvt_pk_bf16_f32 v7, v58, v59
  v_cvt_pk_bf16_f32 v8, v60, v61
  v_cvt_pk_bf16_f32 v9, v62, v63
  v_lshlrev_b32 v48, 16, v2
  v_and_b32 v49, s46, v2
  v_lshlrev_b32 v50, 16, v3
  v_and_b32 v51, s46, v3
  v_lshlrev_b32 v52, 16, v4
  v_and_b32 v53, s46, v4
  v_lshlrev_b32 v54, 16, v5
  v_and_b32 v55, s46, v5
  v_lshlrev_b32 v56, 16, v6
  v_and_b32 v57, s46, v6
  v_lshlrev_b32 v58, 16, v7
  v_and_b32 v59, s46, v7
  v_lshlrev_b32 v60, 16, v8
  v_and_b32 v61, s46, v8
  v_lshlrev_b32 v62, 16, v9
  v_and_b32 v63, s46, v9
  v_pk_mul_f32 v[48:49], v[48:49], v[32:33] op_sel:[0,1] op_sel_hi:[1,1]
  v_pk_mul_f32 v[50:51], v[50:51], v[34:35] op_sel:[0,1] op_sel_hi:[1,1]
  v_pk_mul_f32 v[52:53], v[52:53], v[36:37] op_sel:[0,1] op_sel_hi:[1,1]
  v_pk_mul_f32 v[54:55], v[54:55], v[38:39] op_sel:[0,1] op_sel_hi:[1,1]
  v_pk_mul_f32 v[56:57], v[56:57], v[40:41] op_sel:[0,1] op_sel_hi:[1,1]
  v_pk_mul_f32 v[58:59], v[58:59], v[42:43] op_sel:[0,1] op_sel_hi:[1,1]
  v_pk_mul_f32 v[60:61], v[60:61], v[44:45] op_sel:[0,1] op_sel_hi:[1,1]
  v_pk_mul_f32 v[62:63], v[62:63], v[46:47] op_sel:[0,1] op_sel_hi:[1,1]
  v_cvt_pk_bf16_f32 v64, v48, v50
  v_cvt_pk_bf16_f32 v68, v49, v51
  v_cvt_pk_bf16_f32 v65, v52, v54
  v_cvt_pk_bf16_f32 v69, v53, v55
  v_cvt_pk_bf16_f32 v66, v56, v58
  v_cvt_pk_bf16_f32 v70, v57, v59
  v_cvt_pk_bf16_f32 v67, v60, v62
  v_cvt_pk_bf16_f32 v71, v61, v63
  ds_write_b128 v24, v[64:67]
  ds_write_b128 v24, v[68:71] offset:4608
  s_cmp_lg_u32 s33, 4
  s_cbranch_scc1 L_kall_nopad
  v_mov_b32 v60, 0
  v_mov_b32 v61, 0
  v_mov_b32 v62, 0
  v_mov_b32 v63, 0
  v_lshrrev_b32 v34, 5, v1
  s_movk_i32 s43, 4608
  v_mul_u32_u24 v34, s43, v34
  v_and_b32 v35, 31, v1
  v_lshl_add_u32 v34, v35, 4, v34
  v_add_u32 v34, 124224, v34
  ds_write_b128 v34, v[60:63]
L_kall_nopad:
  v_and_b32 v37, 15, v1
  v_lshlrev_b32 v37, 5, v37
  v_lshrrev_b32 v38, 4, v1
  v_lshl_add_u32 v37, v38, 3, v37
  s_lshl_b32 s44, s36, 2
  s_add_u32 s44, s44, 2
  s_lshl_b32 s44, s44, 9
  v_add_u32 v37, s44, v37
  s_mul_i32 s42, s35, 4608
  s_add_u32 s42, s42, 124736
  v_add_u32 v32, s42, v37
  s_lshl_b32 s42, s35, 12
  s_add_u32 s42, s42, 133440
  v_add_u32 v33, s42, v37
  s_lshl_b32 s42, s37, 12
  s_add_u32 s42, s42, 65536
  v_add_u32 v35, s42, v37
  v_mov_b32 v36, s41
  s_waitcnt lgkmcnt(0)
  s_barrier
  s_lshl_b32 s42, s35, 14
  s_lshl_b32 s43, s36, 12
  s_add_u32 s42, s42, s43
  s_add_u32 s42, s42, 18688
  v_lshl_add_u32 v29, v1, 4, s42
  s_and_b32 s54, s3, 7
  s_lshr_b32 s54, s54, 2
  s_mul_i32 s54, s54, 7
  s_lshr_b32 s55, s3, 5
  s_add_u32 s54, s54, s55
  v_lshrrev_b32 v34, 4, v1
  s_lshl_b32 s55, s53, 2
  v_add_u32 v34, s55, v34
  s_movk_i32 s55, 3584
  v_mul_lo_u32 v34, v34, s55
  v_and_b32 v39, 15, v1
  v_lshl_add_u32 v34, v39, 4, v34
  s_lshl_b32 s54, s54, 8
  v_add_u32 v34, s54, v34
  global_load_dwordx4 v[96:99], v34, s[28:29]
  global_load_dwordx4 v[100:103], v34, s[30:31]
  v_add_u32 v34, 57344, v34
  global_load_dwordx4 v[104:107], v34, s[28:29]
  global_load_dwordx4 v[108:111], v34, s[30:31]
  v_add_u32 v34, 57344, v34
  global_load_dwordx4 v[112:115], v34, s[28:29]
  global_load_dwordx4 v[116:119], v34, s[30:31]
  v_add_u32 v34, 57344, v34
  global_load_dwordx4 v[120:123], v34, s[28:29]
  global_load_dwordx4 v[124:127], v34, s[30:31]
  v_add_u32 v34, 57344, v34
  global_load_dwordx4 v[96:99], v34, s[28:29]
  global_load_dwordx4 v[100:103], v34, s[30:31]
  v_add_u32 v34, 57344, v34
  global_load_dwordx4 v[104:107], v34, s[28:29]
  global_load_dwordx4 v[108:111], v34, s[30:31]
  v_add_u32 v34, 57344, v34
  global_load_dwordx4 v[112:115], v34, s[28:29]
  global_load_dwordx4 v[116:119], v34, s[30:31]
  v_add_u32 v34, 57344, v34
  global_load_dwordx4 v[120:123], v34, s[28:29]
  global_load_dwordx4 v[124:127], v34, s[30:31]
  v_add_u32 v34, 57344, v34
  global_load_dwordx4 v[96:99], v34, s[28:29]
  global_load_dwordx4 v[100:103], v34, s[30:31]
  v_add_u32 v34, 57344, v34
  global_load_dwordx4 v[104:107], v34, s[28:29]
  global_load_dwordx4 v[108:111], v34, s[30:31]
  v_add_u32 v34, 57344, v34
  ds_read_b64 v[48:49], v32
  ds_read_b64 v[50:51], v32 offset:512
  ds_read_b64 v[52:53], v33
  ds_read_b64 v[54:55], v33 offset:512
  s_waitcnt lgkmcnt(0)
  v_lshlrev_b32 v56, 16, v48
  v_and_b32 v57, s46, v48
  v_lshlrev_b32 v58, 16, v49
  v_and_b32 v59, s46, v49
  v_lshlrev_b32 v40, 16, v52
  v_and_b32 v41, s46, v52
  v_lshlrev_b32 v42, 16, v53
  v_and_b32 v43, s46, v53
  v_pk_fma_f32 v[40:41], v[56:57], v[36:37], v[40:41] op_sel_hi:[1,0,1]
  v_pk_fma_f32 v[42:43], v[58:59], v[36:37], v[42:43] op_sel_hi:[1,0,1]
  v_lshlrev_b32 v56, 16, v50
  v_and_b32 v57, s46, v50
  v_lshlrev_b32 v58, 16, v51
  v_and_b32 v59, s46, v51
  v_lshlrev_b32 v44, 16, v54
  v_and_b32 v45, s46, v54
  v_lshlrev_b32 v46, 16, v55
  v_and_b32 v47, s46, v55
  v_pk_fma_f32 v[44:45], v[56:57], v[36:37], v[44:45] op_sel_hi:[1,0,1]
  v_pk_fma_f32 v[46:47], v[58:59], v[36:37], v[46:47] op_sel_hi:[1,0,1]
  s_barrier
  ds_read_b128 v[64:67], v29
  ds_read_b128 v[68:71], v29 offset:1024
  ds_read_b128 v[72:75], v29 offset:8192
  ds_read_b128 v[76:79], v29 offset:9216
  s_waitcnt lgkmcnt(0)
  v_pk_add_f32 v[64:65], v[64:65], v[72:73]
  v_pk_add_f32 v[66:67], v[66:67], v[74:75]
  v_pk_add_f32 v[68:69], v[68:69], v[76:77]
  v_pk_add_f32 v[70:71], v[70:71], v[78:79]
L_kall_fin:
  v_pk_add_f32 v[64:65], v[64:65], v[40:41]
  v_pk_add_f32 v[66:67], v[66:67], v[42:43]
  v_cvt_pk_bf16_f32 v56, v64, v65
  v_cvt_pk_bf16_f32 v57, v66, v67
  global_store_dwordx2 v35, v[56:57], s[26:27] offset:0 sc1
  v_pk_add_f32 v[68:69], v[68:69], v[44:45]
  v_pk_add_f32 v[70:71], v[70:71], v[46:47]
  v_cvt_pk_bf16_f32 v58, v68, v69
  v_cvt_pk_bf16_f32 v59, v70, v71
  global_store_dwordx2 v35, v[58:59], s[26:27] offset:512 sc1
  s_load_dwordx4 s[8:11], s[0:1], 80
  s_load_dwordx2 s[12:13], s[0:1], 120
  s_load_dwordx4 s[4:7], s[0:1], 96
  s_sub_u32 s3, s2, 32
  s_and_b32 s34, s3, 7
  s_lshr_b32 s35, s3, 3
  s_and_b32 s36, s34, 3
  s_lshl_b32 s36, s36, 2
  s_and_b32 s37, s35, 3
  s_add_u32 s36, s36, s37
  s_lshr_b32 s59, s34, 2
  s_mul_i32 s37, s59, 7
  s_lshr_b32 s60, s35, 2
  s_add_u32 s37, s37, s60
  s_and_b32 s38, s33, 3
  s_lshr_b32 s39, s33, 2
  v_lshrrev_b32 v4, 4, v1
  s_lshr_b32 s40, s33, 1
  s_and_b32 s40, s40, 1
  s_lshl_b32 s40, s40, 2
  v_or_b32 v5, s40, v4
  v_lshlrev_b32 v5, 1, v5
  v_and_b32 v6, 15, v1
  v_xor_b32 v5, v5, v6
  v_lshlrev_b32 v5, 4, v5
  s_lshl_b32 s40, s33, 2
  v_add_u32 v4, s40, v4
  v_lshlrev_b32 v2, 12, v4
  s_lshl_b32 s40, s36, 8
  v_add3_u32 v2, v2, v5, s40
  s_movk_i32 s41, 3584
  v_mul_lo_u32 v3, v4, s41
  s_lshl_b32 s40, s37, 8
  v_add3_u32 v3, v3, v5, s40
  s_lshl_b32 s42, s33, 10
  s_mov_b32 s50, 131072
  s_mov_b32 s51, 114688
  s_mov_b32 s18, 1835008
  s_mov_b32 s19, 0x20000
  s_mov_b32 s22, 1605632
  s_mov_b32 s23, 0x20000
  s_mov_b32 s26, 1605632
  s_mov_b32 s27, 0x20000
  v_lshrrev_b32 v11, 4, v1
  v_lshlrev_b32 v11, 2, v11
  s_lshl_b32 s40, s37, 7
  s_lshl_b32 s41, s38, 5
  s_add_u32 s40, s40, s41
  v_add_u32 v11, s40, v11
  s_movk_i32 s41, 2341
  v_add_u32 v12, 0, v11
  v_mul_u32_u24 v13, s41, v12
  v_lshrrev_b32 v13, 18, v13
  v_mul_u32_u24 v14, 112, v13
  v_sub_u32 v12, v12, v14
  v_lshlrev_b32 v12, 2, v12
  v_lshl_add_u32 v12, v13, 9, v12
  v_add_u32 v16, 16384, v12
  v_add_u32 v12, 16, v11
  v_mul_u32_u24 v13, s41, v12
  v_lshrrev_b32 v13, 18, v13
  v_mul_u32_u24 v14, 112, v13
  v_sub_u32 v12, v12, v14
  v_lshlrev_b32 v12, 2, v12
  v_lshl_add_u32 v12, v13, 9, v12
  v_add_u32 v17, 16384, v12
  v_add_u32 v12, 1792, v11
  v_mul_u32_u24 v13, s41, v12
  v_lshrrev_b32 v13, 18, v13
  v_mul_u32_u24 v14, 112, v13
  v_sub_u32 v12, v12, v14
  v_lshlrev_b32 v12, 2, v12
  v_lshl_add_u32 v12, v13, 9, v12
  v_add_u32 v18, 16384, v12
  v_add_u32 v12, 1808, v11
  v_mul_u32_u24 v13, s41, v12
  v_lshrrev_b32 v13, 18, v13
  v_mul_u32_u24 v14, 112, v13
  v_sub_u32 v12, v12, v14
  v_lshlrev_b32 v12, 2, v12
  v_lshl_add_u32 v12, v13, 9, v12
  v_add_u32 v19, 16384, v12
  v_lshrrev_b32 v10, 3, v1
  s_lshl_b32 s40, s38, 3
  v_add_u32 v10, s40, v10
  s_movk_i32 s41, 896
  v_mul_lo_u32 v10, v10, s41
  v_lshrrev_b32 v11, 4, v1
  v_lshlrev_b32 v11, 1, v11
  v_and_b32 v12, 7, v1
  v_xor_b32 v11, v11, v12
  v_lshlrev_b32 v11, 4, v11
  s_lshl_b32 s40, s60, 7
  v_add3_u32 v10, v10, v11, s40
  v_lshrrev_b32 v14, 4, v1
  v_bfe_u32 v11, v1, 2, 2
  v_lshl_add_u32 v12, v14, 3, v11
  v_lshlrev_b32 v12, 8, v12
  v_and_b32 v13, 3, v1
  v_lshl_add_u32 v12, v13, 3, v12
  v_and_b32 v14, 1, v14
  v_lshl_or_b32 v11, v14, 2, v11
  s_lshl_b32 s40, s38, 1
  s_add_u32 s40, s40, 0
  v_xor_b32 v13, s40, v11
  v_lshl_add_u32 v4, v13, 5, v12
  s_lshl_b32 s40, s38, 1
  s_add_u32 s40, s40, 1
  v_xor_b32 v13, s40, v11
  v_lshl_add_u32 v5, v13, 5, v12
  s_lshl_b32 s40, s39, 2
  s_add_u32 s40, s40, 0
  v_xor_b32 v13, s40, v11
  v_lshl_add_u32 v6, v13, 5, v12
  s_lshl_b32 s40, s39, 2
  s_add_u32 s40, s40, 1
  v_xor_b32 v13, s40, v11
  v_lshl_add_u32 v7, v13, 5, v12
  s_lshl_b32 s40, s39, 2
  s_add_u32 s40, s40, 2
  v_xor_b32 v13, s40, v11
  v_lshl_add_u32 v8, v13, 5, v12
  s_lshl_b32 s40, s39, 2
  s_add_u32 s40, s40, 3
  v_xor_b32 v13, s40, v11
  v_lshl_add_u32 v9, v13, 5, v12
  v_add_u32 v20, 24576, v4
  v_add_u32 v21, 24576, v5
  v_add_u32 v22, 24576, v6
  v_add_u32 v23, 24576, v7
  v_add_u32 v24, 24576, v8
  v_add_u32 v25, 24576, v9
  s_mov_b32 s30, 7340032
  s_mov_b32 s31, 0x20000
  s_waitcnt lgkmcnt(0)
  s_waitcnt vmcnt(0)
  s_barrier
  s_cmp_lg_u32 s33, 0
  s_cbranch_scc1 L_kallg_s2na
  s_and_b32 s40, s2, 7
  s_lshl_b32 s40, s40, 7
  s_add_u32 s41, s40, 51200
  v_mov_b32 v12, s41
  v_mov_b32 v13, 1
  s_mov_b64 s[56:57], exec
  s_mov_b64 exec, 1
  global_atomic_add v14, v12, v13, s[12:13] sc0 sc1
  s_mov_b64 exec, s[56:57]
L_kallg_s2na:
  s_mov_b32 s20, s8
  s_mov_b32 s21, s9
  s_mov_b32 s24, s10
  s_mov_b32 s25, s11
  s_cmp_eq_u32 s33, 0
  s_cbranch_scc1 L_kallg_s2ne
  s_add_u32 m0, s42, 8192
  s_nop 0
  buffer_load_dwordx4 v3, s[20:23], 0 offen lds
  s_add_u32 m0, s42, 16384
  s_nop 0
  buffer_load_dwordx4 v3, s[24:27], 0 offen lds
  v_add_u32 v3, s51, v3
  s_add_u32 m0, s42, 32768
  s_nop 0
  buffer_load_dwordx4 v3, s[20:23], 0 offen lds
  s_add_u32 m0, s42, 40960
  s_nop 0
  buffer_load_dwordx4 v3, s[24:27], 0 offen lds
  v_add_u32 v3, s51, v3
  s_add_u32 m0, s42, 57344
  s_nop 0
  buffer_load_dwordx4 v3, s[20:23], 0 offen lds
  s_add_u32 m0, s42, 65536
  s_nop 0
  buffer_load_dwordx4 v3, s[24:27], 0 offen lds
  v_add_u32 v3, s51, v3
L_kallg_s2ne:
  s_cmp_lg_u32 s33, 0
  s_cbranch_scc1 L_kallg_s2w
  s_waitcnt vmcnt(0)
  v_readfirstlane_b32 s41, v14
  s_nop 0
  s_cmp_lg_u32 s41, 27
  s_cbranch_scc1 L_kallg_s2nl
  v_lshlrev_b32 v12, 7, v1
  v_add_u32 v12, 52224, v12
  s_mov_b64 exec, 0xff
  global_atomic_add v12, v13, s[12:13] sc1
  s_mov_b64 exec, s[56:57]
L_kallg_s2nl:
  s_add_u32 s41, s40, 52224
  v_mov_b32 v12, s41
  s_mov_b32 s58, 0
L_kallg_s2p:
  global_load_dword v13, v12, s[12:13] sc1
  s_waitcnt vmcnt(0)
  v_readfirstlane_b32 s41, v13
  s_add_u32 s58, s58, 1
  s_cmp_ge_u32 s41, 8
  s_cbranch_scc1 L_kallg_s2w
  s_cmp_ge_u32 s58, 0x40000
  s_cbranch_scc1 L_kallg_s2w
  s_sleep 1
  s_branch L_kallg_s2p
L_kallg_s2w:
  s_barrier
  s_cmp_lg_u32 s33, 0
  s_cbranch_scc1 L_kallg_s2nf
  s_add_u32 m0, s42, 8192
  s_nop 0
  buffer_load_dwordx4 v3, s[20:23], 0 offen lds
  s_add_u32 m0, s42, 16384
  s_nop 0
  buffer_load_dwordx4 v3, s[24:27], 0 offen lds
  v_add_u32 v3, s51, v3
  s_add_u32 m0, s42, 32768
  s_nop 0
  buffer_load_dwordx4 v3, s[20:23], 0 offen lds
  s_add_u32 m0, s42, 40960
  s_nop 0
  buffer_load_dwordx4 v3, s[24:27], 0 offen lds
  v_add_u32 v3, s51, v3
  s_add_u32 m0, s42, 57344
  s_nop 0
  buffer_load_dwordx4 v3, s[20:23], 0 offen lds
  s_add_u32 m0, s42, 65536
  s_nop 0
  buffer_load_dwordx4 v3, s[24:27], 0 offen lds
  v_add_u32 v3, s51, v3
L_kallg_s2nf:
  s_add_u32 s16, s12, 65536
  s_addc_u32 s17, s13, 0
  s_mov_b32 s20, s8
  s_mov_b32 s21, s9
  s_mov_b32 s24, s10
  s_mov_b32 s25, s11
  s_add_u32 m0, s42, 0
  s_nop 0
  buffer_load_dwordx4 v2, s[16:19], 0 offen sc1 lds
  v_add_u32 v2, s50, v2
  s_add_u32 m0, s42, 24576
  s_nop 0
  buffer_load_dwordx4 v2, s[16:19], 0 offen sc1 lds
  v_add_u32 v2, s50, v2
  s_add_u32 m0, s42, 49152
  s_nop 0
  buffer_load_dwordx4 v2, s[16:19], 0 offen sc1 lds
  v_add_u32 v2, s50, v2
  s_add_u32 s28, s12, 2097152
  s_addc_u32 s29, s13, 0
  s_mov_b32 s8, s4
  s_mov_b32 s9, s5
  s_mov_b32 s10, 1605632
  s_mov_b32 s11, 0x20000
  s_mov_b32 s4, s6
  s_mov_b32 s5, s7
  s_mov_b32 s6, 1835008
  s_mov_b32 s7, 0x20000
  s_waitcnt vmcnt(2)
  s_barrier
  ds_read_b64_tr_b16 v[32:33], v4 offset:8192
  ds_read_b64_tr_b16 v[34:35], v4 offset:9216
  ds_read_b64_tr_b16 v[48:49], v6 offset:0
  ds_read_b64_tr_b16 v[50:51], v6 offset:1024
  ds_read_b64_tr_b16 v[40:41], v4 offset:16384
  ds_read_b64_tr_b16 v[42:43], v4 offset:17408
  ds_read_b64_tr_b16 v[52:53], v7 offset:0
  ds_read_b64_tr_b16 v[54:55], v7 offset:1024
  ds_read_b64_tr_b16 v[36:37], v5 offset:8192
  ds_read_b64_tr_b16 v[38:39], v5 offset:9216
  ds_read_b64_tr_b16 v[44:45], v5 offset:16384
  ds_read_b64_tr_b16 v[46:47], v5 offset:17408
  ds_read_b64_tr_b16 v[56:57], v8 offset:0
  ds_read_b64_tr_b16 v[58:59], v8 offset:1024
  ds_read_b64_tr_b16 v[60:61], v9 offset:0
  ds_read_b64_tr_b16 v[62:63], v9 offset:1024
  s_cmp_eq_u32 s39, 1
  s_cbranch_scc0 L_kallg_np
  s_setprio 1
L_kallg_np:
  s_waitcnt lgkmcnt(12)
  v_mfma_f32_16x16x32_bf16 v[96:99], v[32:35], v[48:51], 0
  s_waitcnt vmcnt(1)
  s_barrier
  ds_read_b64_tr_b16 v[64:65], v20 offset:8192
  s_waitcnt lgkmcnt(11)
  v_mfma_f32_16x16x32_bf16 v[128:131], v[40:43], v[48:51], 0
  ds_read_b64_tr_b16 v[66:67], v20 offset:9216
  s_add_u32 s44, s42, 73728
  s_mov_b32 m0, s44
  s_add_u32 s45, s44, 8192
  buffer_load_dwordx4 v2, s[16:19], 0 offen sc1 lds
  s_waitcnt lgkmcnt(10)
  v_mfma_f32_16x16x32_bf16 v[100:103], v[32:35], v[52:55], 0
  ds_read_b64_tr_b16 v[80:81], v22 offset:0
  v_mfma_f32_16x16x32_bf16 v[132:135], v[40:43], v[52:55], 0
  ds_read_b64_tr_b16 v[82:83], v22 offset:1024
  s_mov_b32 m0, s45
  s_add_u32 s45, s44, 16384
  buffer_load_dwordx4 v3, s[20:23], 0 offen lds
  v_add_u32 v2, s50, v2
  s_waitcnt lgkmcnt(10)
  v_mfma_f32_16x16x32_bf16 v[112:115], v[36:39], v[48:51], 0
  ds_read_b64_tr_b16 v[72:73], v20 offset:16384
  v_mfma_f32_16x16x32_bf16 v[116:119], v[36:39], v[52:55], 0
  ds_read_b64_tr_b16 v[74:75], v20 offset:17408
  s_mov_b32 m0, s45
  s_nop 0
  buffer_load_dwordx4 v3, s[24:27], 0 offen lds
  v_add_u32 v3, s51, v3
  s_waitcnt lgkmcnt(10)
  v_mfma_f32_16x16x32_bf16 v[144:147], v[44:47], v[48:51], 0
  ds_read_b64_tr_b16 v[84:85], v23 offset:0
  v_mfma_f32_16x16x32_bf16 v[148:151], v[44:47], v[52:55], 0
  ds_read_b64_tr_b16 v[86:87], v23 offset:1024
  s_add_u32 s44, s42, 98304
  s_mov_b32 m0, s44
  s_add_u32 s45, s44, 8192
  buffer_load_dwordx4 v2, s[16:19], 0 offen sc1 lds
  s_waitcnt lgkmcnt(10)
  v_mfma_f32_16x16x32_bf16 v[104:107], v[32:35], v[56:59], 0
  ds_read_b64_tr_b16 v[68:69], v21 offset:8192
  v_mfma_f32_16x16x32_bf16 v[136:139], v[40:43], v[56:59], 0
  ds_read_b64_tr_b16 v[70:71], v21 offset:9216
  s_mov_b32 m0, s45
  s_add_u32 s45, s44, 16384
  buffer_load_dwordx4 v3, s[20:23], 0 offen lds
  v_add_u32 v2, s50, v2
  v_mfma_f32_16x16x32_bf16 v[120:123], v[36:39], v[56:59], 0
  ds_read_b64_tr_b16 v[76:77], v21 offset:16384
  v_add_u32 v26, 49152, v4
  v_mfma_f32_16x16x32_bf16 v[152:155], v[44:47], v[56:59], 0
  ds_read_b64_tr_b16 v[78:79], v21 offset:17408
  s_mov_b32 m0, s45
  s_nop 0
  buffer_load_dwordx4 v3, s[24:27], 0 offen lds
  v_add_u32 v3, s51, v3
  v_add_u32 v27, 49152, v5
  s_waitcnt lgkmcnt(12)
  v_mfma_f32_16x16x32_bf16 v[108:111], v[32:35], v[60:63], 0
  ds_read_b64_tr_b16 v[88:89], v24 offset:0
  v_add_u32 v28, 49152, v6
  v_mfma_f32_16x16x32_bf16 v[140:143], v[40:43], v[60:63], 0
  ds_read_b64_tr_b16 v[90:91], v24 offset:1024
  v_add_u32 v29, 49152, v7
  v_mfma_f32_16x16x32_bf16 v[124:127], v[36:39], v[60:63], 0
  ds_read_b64_tr_b16 v[92:93], v25 offset:0
  v_add_u32 v30, 49152, v8
  v_mfma_f32_16x16x32_bf16 v[156:159], v[44:47], v[60:63], 0
  ds_read_b64_tr_b16 v[94:95], v25 offset:1024
  v_add_u32 v31, 49152, v9
  s_waitcnt lgkmcnt(12)
  v_mfma_f32_16x16x32_bf16 v[96:99], v[64:67], v[80:83], v[96:99]
  s_waitcnt vmcnt(6)
  s_barrier
  ds_read_b64_tr_b16 v[32:33], v26 offset:8192
  s_waitcnt lgkmcnt(11)
  v_mfma_f32_16x16x32_bf16 v[128:131], v[72:75], v[80:83], v[128:131]
  ds_read_b64_tr_b16 v[34:35], v26 offset:9216
  s_add_u32 s44, s42, 122880
  s_mov_b32 m0, s44
  s_add_u32 s45, s44, 8192
  buffer_load_dwordx4 v2, s[16:19], 0 offen sc1 lds
  s_waitcnt lgkmcnt(10)
  v_mfma_f32_16x16x32_bf16 v[100:103], v[64:67], v[84:87], v[100:103]
  ds_read_b64_tr_b16 v[48:49], v28 offset:0
  v_mfma_f32_16x16x32_bf16 v[132:135], v[72:75], v[84:87], v[132:135]
  ds_read_b64_tr_b16 v[50:51], v28 offset:1024
  s_mov_b32 m0, s45
  s_add_u32 s45, s44, 16384
  buffer_load_dwordx4 v3, s[20:23], 0 offen lds
  v_add_u32 v2, s50, v2
  s_waitcnt lgkmcnt(10)
  v_mfma_f32_16x16x32_bf16 v[112:115], v[68:71], v[80:83], v[112:115]
  ds_read_b64_tr_b16 v[40:41], v26 offset:16384
  v_mfma_f32_16x16x32_bf16 v[116:119], v[68:71], v[84:87], v[116:119]
  ds_read_b64_tr_b16 v[42:43], v26 offset:17408
  s_mov_b32 m0, s45
  s_nop 0
  buffer_load_dwordx4 v3, s[24:27], 0 offen lds
  v_add_u32 v3, s51, v3
  s_waitcnt lgkmcnt(10)
  v_mfma_f32_16x16x32_bf16 v[144:147], v[76:79], v[80:83], v[144:147]
  ds_read_b64_tr_b16 v[52:53], v29 offset:0
  v_mfma_f32_16x16x32_bf16 v[148:151], v[76:79], v[84:87], v[148:151]
  ds_read_b64_tr_b16 v[54:55], v29 offset:1024
  s_add_u32 s44, s42, 0
  s_mov_b32 m0, s44
  s_add_u32 s45, s44, 8192
  buffer_load_dwordx4 v2, s[16:19], 0 offen sc1 lds
  s_waitcnt lgkmcnt(10)
  v_mfma_f32_16x16x32_bf16 v[104:107], v[64:67], v[88:91], v[104:107]
  ds_read_b64_tr_b16 v[36:37], v27 offset:8192
  v_mfma_f32_16x16x32_bf16 v[136:139], v[72:75], v[88:91], v[136:139]
  ds_read_b64_tr_b16 v[38:39], v27 offset:9216
  s_mov_b32 m0, s45
  s_add_u32 s45, s44, 16384
  buffer_load_dwordx4 v3, s[20:23], 0 offen lds
  v_add_u32 v2, s50, v2
  v_mfma_f32_16x16x32_bf16 v[120:123], v[68:71], v[88:91], v[120:123]
  ds_read_b64_tr_b16 v[44:45], v27 offset:16384
  v_add_u32 v20, 73728, v4
  v_mfma_f32_16x16x32_bf16 v[152:155], v[76:79], v[88:91], v[152:155]
  ds_read_b64_tr_b16 v[46:47], v27 offset:17408
  s_mov_b32 m0, s45
  s_nop 0
  buffer_load_dwordx4 v3, s[24:27], 0 offen lds
  v_add_u32 v3, s51, v3
  v_add_u32 v21, 73728, v5
  s_waitcnt lgkmcnt(12)
  v_mfma_f32_16x16x32_bf16 v[108:111], v[64:67], v[92:95], v[108:111]
  ds_read_b64_tr_b16 v[56:57], v30 offset:0
  v_add_u32 v22, 73728, v6
  v_mfma_f32_16x16x32_bf16 v[140:143], v[72:75], v[92:95], v[140:143]
  ds_read_b64_tr_b16 v[58:59], v30 offset:1024
  v_add_u32 v23, 73728, v7
  v_mfma_f32_16x16x32_bf16 v[124:127], v[68:71], v[92:95], v[124:127]
  ds_read_b64_tr_b16 v[60:61], v31 offset:0
  v_add_u32 v24, 73728, v8
  v_mfma_f32_16x16x32_bf16 v[156:159], v[76:79], v[92:95], v[156:159]
  ds_read_b64_tr_b16 v[62:63], v31 offset:1024
  v_add_u32 v25, 73728, v9
  s_mov_b32 s48, 0
  s_mov_b32 s53, 98304
  s_add_u32 s54, s42, 24576
L_kallg_loop0:
  s_waitcnt lgkmcnt(12)
  v_mfma_f32_16x16x32_bf16 v[96:99], v[32:35], v[48:51], v[96:99]
  s_waitcnt vmcnt(9)
  s_barrier
  ds_read_b64_tr_b16 v[64:65], v20 offset:8192
  s_waitcnt lgkmcnt(11)
  v_mfma_f32_16x16x32_bf16 v[128:131], v[40:43], v[48:51], v[128:131]
  ds_read_b64_tr_b16 v[66:67], v20 offset:9216
  s_mov_b32 m0, s54
  s_waitcnt lgkmcnt(10)
  v_mfma_f32_16x16x32_bf16 v[100:103], v[32:35], v[52:55], v[100:103]
  ds_read_b64_tr_b16 v[80:81], v22 offset:0
  buffer_load_dwordx4 v2, s[16:19], 0 offen sc1 lds
  v_mfma_f32_16x16x32_bf16 v[132:135], v[40:43], v[52:55], v[132:135]
  ds_read_b64_tr_b16 v[82:83], v22 offset:1024
  s_add_u32 m0, s54, 8192
  v_add_u32 v2, s50, v2
  s_waitcnt lgkmcnt(10)
  v_mfma_f32_16x16x32_bf16 v[112:115], v[36:39], v[48:51], v[112:115]
  ds_read_b64_tr_b16 v[72:73], v20 offset:16384
  buffer_load_dwordx4 v3, s[20:23], 0 offen lds
  v_mfma_f32_16x16x32_bf16 v[116:119], v[36:39], v[52:55], v[116:119]
  ds_read_b64_tr_b16 v[74:75], v20 offset:17408
  s_add_u32 m0, s54, 16384
  s_waitcnt lgkmcnt(10)
  v_mfma_f32_16x16x32_bf16 v[144:147], v[44:47], v[48:51], v[144:147]
  ds_read_b64_tr_b16 v[84:85], v23 offset:0
  buffer_load_dwordx4 v3, s[24:27], 0 offen lds
  v_mfma_f32_16x16x32_bf16 v[148:151], v[44:47], v[52:55], v[148:151]
  ds_read_b64_tr_b16 v[86:87], v23 offset:1024
  v_add_u32 v3, s51, v3
  s_add_u32 s54, s54, 24576
  s_waitcnt lgkmcnt(10)
  v_mfma_f32_16x16x32_bf16 v[104:107], v[32:35], v[56:59], v[104:107]
  ds_read_b64_tr_b16 v[68:69], v21 offset:8192
  s_sub_u32 s55, s54, s42
  v_mfma_f32_16x16x32_bf16 v[136:139], v[40:43], v[56:59], v[136:139]
  ds_read_b64_tr_b16 v[70:71], v21 offset:9216
  s_cmp_eq_u32 s55, 147456
  s_cselect_b32 s54, s42, s54
  v_add_u32 v26, s53, v4
  v_mfma_f32_16x16x32_bf16 v[120:123], v[36:39], v[56:59], v[120:123]
  ds_read_b64_tr_b16 v[76:77], v21 offset:16384
  v_add_u32 v27, s53, v5
  v_add_u32 v28, s53, v6
  v_mfma_f32_16x16x32_bf16 v[152:155], v[44:47], v[56:59], v[152:155]
  ds_read_b64_tr_b16 v[78:79], v21 offset:17408
  v_add_u32 v29, s53, v7
  v_add_u32 v30, s53, v8
  s_waitcnt lgkmcnt(12)
  v_mfma_f32_16x16x32_bf16 v[108:111], v[32:35], v[60:63], v[108:111]
  ds_read_b64_tr_b16 v[88:89], v24 offset:0
  v_add_u32 v31, s53, v9
  v_mfma_f32_16x16x32_bf16 v[140:143], v[40:43], v[60:63], v[140:143]
  ds_read_b64_tr_b16 v[90:91], v24 offset:1024
  s_add_u32 s53, s53, 24576
  v_mfma_f32_16x16x32_bf16 v[124:127], v[36:39], v[60:63], v[124:127]
  ds_read_b64_tr_b16 v[92:93], v25 offset:0
  s_cmp_eq_u32 s53, 147456
  s_cselect_b32 s53, 0, s53
  v_mfma_f32_16x16x32_bf16 v[156:159], v[44:47], v[60:63], v[156:159]
  ds_read_b64_tr_b16 v[94:95], v25 offset:1024
  s_waitcnt lgkmcnt(12)
  v_mfma_f32_16x16x32_bf16 v[96:99], v[64:67], v[80:83], v[96:99]
  s_waitcnt vmcnt(9)
  s_barrier
  ds_read_b64_tr_b16 v[32:33], v26 offset:8192
  s_waitcnt lgkmcnt(11)
  v_mfma_f32_16x16x32_bf16 v[128:131], v[72:75], v[80:83], v[128:131]
  ds_read_b64_tr_b16 v[34:35], v26 offset:9216
  s_mov_b32 m0, s54
  s_waitcnt lgkmcnt(10)
  v_mfma_f32_16x16x32_bf16 v[100:103], v[64:67], v[84:87], v[100:103]
  ds_read_b64_tr_b16 v[48:49], v28 offset:0
  buffer_load_dwordx4 v2, s[16:19], 0 offen sc1 lds
  v_mfma_f32_16x16x32_bf16 v[132:135], v[72:75], v[84:87], v[132:135]
  ds_read_b64_tr_b16 v[50:51], v28 offset:1024
  s_add_u32 m0, s54, 8192
  v_add_u32 v2, s50, v2
  s_waitcnt lgkmcnt(10)
  v_mfma_f32_16x16x32_bf16 v[112:115], v[68:71], v[80:83], v[112:115]
  ds_read_b64_tr_b16 v[40:41], v26 offset:16384
  buffer_load_dwordx4 v3, s[20:23], 0 offen lds
  v_mfma_f32_16x16x32_bf16 v[116:119], v[68:71], v[84:87], v[116:119]
  ds_read_b64_tr_b16 v[42:43], v26 offset:17408
  s_add_u32 m0, s54, 16384
  s_waitcnt lgkmcnt(10)
  v_mfma_f32_16x16x32_bf16 v[144:147], v[76:79], v[80:83], v[144:147]
  ds_read_b64_tr_b16 v[52:53], v29 offset:0
  buffer_load_dwordx4 v3, s[24:27], 0 offen lds
  v_mfma_f32_16x16x32_bf16 v[148:151], v[76:79], v[84:87], v[148:151]
  ds_read_b64_tr_b16 v[54:55], v29 offset:1024
  v_add_u32 v3, s51, v3
  s_add_u32 s54, s54, 24576
  s_waitcnt lgkmcnt(10)
  v_mfma_f32_16x16x32_bf16 v[104:107], v[64:67], v[88:91], v[104:107]
  ds_read_b64_tr_b16 v[36:37], v27 offset:8192
  s_sub_u32 s55, s54, s42
  v_mfma_f32_16x16x32_bf16 v[136:139], v[72:75], v[88:91], v[136:139]
  ds_read_b64_tr_b16 v[38:39], v27 offset:9216
  s_cmp_eq_u32 s55, 147456
  s_cselect_b32 s54, s42, s54
  v_add_u32 v20, s53, v4
  v_mfma_f32_16x16x32_bf16 v[120:123], v[68:71], v[88:91], v[120:123]
  ds_read_b64_tr_b16 v[44:45], v27 offset:16384
  v_add_u32 v21, s53, v5
  v_add_u32 v22, s53, v6
  v_mfma_f32_16x16x32_bf16 v[152:155], v[76:79], v[88:91], v[152:155]
  ds_read_b64_tr_b16 v[46:47], v27 offset:17408
  v_add_u32 v23, s53, v7
  v_add_u32 v24, s53, v8
  s_waitcnt lgkmcnt(12)
  v_mfma_f32_16x16x32_bf16 v[108:111], v[64:67], v[92:95], v[108:111]
  ds_read_b64_tr_b16 v[56:57], v30 offset:0
  v_add_u32 v25, s53, v9
  v_mfma_f32_16x16x32_bf16 v[140:143], v[72:75], v[92:95], v[140:143]
  ds_read_b64_tr_b16 v[58:59], v30 offset:1024
  s_add_u32 s53, s53, 24576
  v_mfma_f32_16x16x32_bf16 v[124:127], v[68:71], v[92:95], v[124:127]
  ds_read_b64_tr_b16 v[60:61], v31 offset:0
  s_cmp_eq_u32 s53, 147456
  s_cselect_b32 s53, 0, s53
  v_mfma_f32_16x16x32_bf16 v[156:159], v[76:79], v[92:95], v[156:159]
  ds_read_b64_tr_b16 v[62:63], v31 offset:1024
  s_add_u32 s48, s48, 1
  s_cmp_lt_u32 s48, 3
  s_cbranch_scc1 L_kallg_loop0
  s_mul_i32 s46, s39, 28672
  s_add_u32 m0, s42, 147456
  s_add_u32 s46, s46, 0
  buffer_load_dwordx4 v10, s[8:11], s46 offen lds
  s_mul_i32 s46, s39, 28672
  s_add_u32 m0, s42, 155648
  s_add_u32 s46, s46, 57344
  buffer_load_dwordx4 v10, s[8:11], s46 offen lds
  s_waitcnt lgkmcnt(12)
  v_mfma_f32_16x16x32_bf16 v[96:99], v[32:35], v[48:51], v[96:99]
  s_waitcnt vmcnt(11)
  s_barrier
  ds_read_b64_tr_b16 v[64:65], v20 offset:8192
  s_waitcnt lgkmcnt(11)
  v_mfma_f32_16x16x32_bf16 v[128:131], v[40:43], v[48:51], v[128:131]
  ds_read_b64_tr_b16 v[66:67], v20 offset:9216
  s_waitcnt lgkmcnt(10)
  v_mfma_f32_16x16x32_bf16 v[100:103], v[32:35], v[52:55], v[100:103]
  ds_read_b64_tr_b16 v[80:81], v22 offset:0
  s_add_u32 s44, s42, 24576
  s_mov_b32 m0, s44
  s_add_u32 s45, s44, 8192
  buffer_load_dwordx4 v2, s[16:19], 0 offen sc1 lds
  v_mfma_f32_16x16x32_bf16 v[132:135], v[40:43], v[52:55], v[132:135]
  ds_read_b64_tr_b16 v[82:83], v22 offset:1024
  s_waitcnt lgkmcnt(10)
  v_mfma_f32_16x16x32_bf16 v[112:115], v[36:39], v[48:51], v[112:115]
  ds_read_b64_tr_b16 v[72:73], v20 offset:16384
  v_mfma_f32_16x16x32_bf16 v[116:119], v[36:39], v[52:55], v[116:119]
  ds_read_b64_tr_b16 v[74:75], v20 offset:17408
  s_mov_b32 m0, s45
  s_add_u32 s45, s44, 16384
  buffer_load_dwordx4 v3, s[20:23], 0 offen lds
  v_add_u32 v2, s50, v2
  s_waitcnt lgkmcnt(10)
  v_mfma_f32_16x16x32_bf16 v[144:147], v[44:47], v[48:51], v[144:147]
  ds_read_b64_tr_b16 v[84:85], v23 offset:0
  v_mfma_f32_16x16x32_bf16 v[148:151], v[44:47], v[52:55], v[148:151]
  ds_read_b64_tr_b16 v[86:87], v23 offset:1024
  s_waitcnt lgkmcnt(10)
  v_mfma_f32_16x16x32_bf16 v[104:107], v[32:35], v[56:59], v[104:107]
  ds_read_b64_tr_b16 v[68:69], v21 offset:8192
  s_mov_b32 m0, s45
  s_nop 0
  buffer_load_dwordx4 v3, s[24:27], 0 offen lds
  v_add_u32 v3, s51, v3
  v_mfma_f32_16x16x32_bf16 v[136:139], v[40:43], v[56:59], v[136:139]
  ds_read_b64_tr_b16 v[70:71], v21 offset:9216
  v_mfma_f32_16x16x32_bf16 v[120:123], v[36:39], v[56:59], v[120:123]
  ds_read_b64_tr_b16 v[76:77], v21 offset:16384
  v_add_u32 v26, 98304, v4
  v_mfma_f32_16x16x32_bf16 v[152:155], v[44:47], v[56:59], v[152:155]
  ds_read_b64_tr_b16 v[78:79], v21 offset:17408
  v_add_u32 v27, 98304, v5
  s_waitcnt lgkmcnt(12)
  v_mfma_f32_16x16x32_bf16 v[108:111], v[32:35], v[60:63], v[108:111]
  ds_read_b64_tr_b16 v[88:89], v24 offset:0
  v_add_u32 v28, 98304, v6
  v_mfma_f32_16x16x32_bf16 v[140:143], v[40:43], v[60:63], v[140:143]
  ds_read_b64_tr_b16 v[90:91], v24 offset:1024
  v_add_u32 v29, 98304, v7
  v_mfma_f32_16x16x32_bf16 v[124:127], v[36:39], v[60:63], v[124:127]
  ds_read_b64_tr_b16 v[92:93], v25 offset:0
  v_add_u32 v30, 98304, v8
  v_mfma_f32_16x16x32_bf16 v[156:159], v[44:47], v[60:63], v[156:159]
  ds_read_b64_tr_b16 v[94:95], v25 offset:1024
  v_add_u32 v31, 98304, v9
  s_waitcnt lgkmcnt(12)
  v_mfma_f32_16x16x32_bf16 v[96:99], v[64:67], v[80:83], v[96:99]
  s_waitcnt vmcnt(11)
  s_barrier
  ds_read_b64_tr_b16 v[32:33], v26 offset:8192
  s_waitcnt lgkmcnt(11)
  v_mfma_f32_16x16x32_bf16 v[128:131], v[72:75], v[80:83], v[128:131]
  ds_read_b64_tr_b16 v[34:35], v26 offset:9216
  s_waitcnt lgkmcnt(10)
  v_mfma_f32_16x16x32_bf16 v[100:103], v[64:67], v[84:87], v[100:103]
  ds_read_b64_tr_b16 v[48:49], v28 offset:0
  s_mul_i32 s46, s39, 28672
  s_add_u32 m0, s42, 49152
  s_add_u32 s46, s46, 401408
  buffer_load_dwordx4 v10, s[8:11], s46 offen lds
  v_mfma_f32_16x16x32_bf16 v[132:135], v[72:75], v[84:87], v[132:135]
  ds_read_b64_tr_b16 v[50:51], v28 offset:1024
  s_waitcnt lgkmcnt(10)
  v_mfma_f32_16x16x32_bf16 v[112:115], v[68:71], v[80:83], v[112:115]
  ds_read_b64_tr_b16 v[40:41], v26 offset:16384
  v_mfma_f32_16x16x32_bf16 v[116:119], v[68:71], v[84:87], v[116:119]
  ds_read_b64_tr_b16 v[42:43], v26 offset:17408
  s_mul_i32 s46, s39, 28672
  s_add_u32 m0, s42, 57344
  s_add_u32 s46, s46, 458752
  buffer_load_dwordx4 v10, s[8:11], s46 offen lds
  s_waitcnt lgkmcnt(10)
  v_mfma_f32_16x16x32_bf16 v[144:147], v[76:79], v[80:83], v[144:147]
  ds_read_b64_tr_b16 v[52:53], v29 offset:0
  v_mfma_f32_16x16x32_bf16 v[148:151], v[76:79], v[84:87], v[148:151]
  ds_read_b64_tr_b16 v[54:55], v29 offset:1024
  s_waitcnt lgkmcnt(10)
  v_mfma_f32_16x16x32_bf16 v[104:107], v[64:67], v[88:91], v[104:107]
  ds_read_b64_tr_b16 v[36:37], v27 offset:8192
  s_mul_i32 s46, s39, 28672
  s_add_u32 m0, s42, 65536
  s_add_u32 s46, s46, 802816
  buffer_load_dwordx4 v10, s[8:11], s46 offen lds
  v_mfma_f32_16x16x32_bf16 v[136:139], v[72:75], v[88:91], v[136:139]
  ds_read_b64_tr_b16 v[38:39], v27 offset:9216
  v_mfma_f32_16x16x32_bf16 v[120:123], v[68:71], v[88:91], v[120:123]
  ds_read_b64_tr_b16 v[44:45], v27 offset:16384
  v_add_u32 v20, 122880, v4
  v_mfma_f32_16x16x32_bf16 v[152:155], v[76:79], v[88:91], v[152:155]
  ds_read_b64_tr_b16 v[46:47], v27 offset:17408
  global_load_dwordx4 v[160:163], v16, s[12:13] sc1
  global_load_dwordx4 v[164:167], v17, s[12:13] sc1
  global_load_dwordx4 v[168:171], v18, s[12:13] sc1
  global_load_dwordx4 v[172:175], v19, s[12:13] sc1
  v_add_u32 v21, 122880, v5
  s_waitcnt lgkmcnt(12)
  v_mfma_f32_16x16x32_bf16 v[108:111], v[64:67], v[92:95], v[108:111]
  ds_read_b64_tr_b16 v[56:57], v30 offset:0
  v_add_u32 v22, 122880, v6
  v_mfma_f32_16x16x32_bf16 v[140:143], v[72:75], v[92:95], v[140:143]
  ds_read_b64_tr_b16 v[58:59], v30 offset:1024
  v_add_u32 v23, 122880, v7
  v_mfma_f32_16x16x32_bf16 v[124:127], v[68:71], v[92:95], v[124:127]
  ds_read_b64_tr_b16 v[60:61], v31 offset:0
  v_add_u32 v24, 122880, v8
  v_mfma_f32_16x16x32_bf16 v[156:159], v[76:79], v[92:95], v[156:159]
  ds_read_b64_tr_b16 v[62:63], v31 offset:1024
  v_add_u32 v25, 122880, v9
  s_waitcnt lgkmcnt(12)
  v_mfma_f32_16x16x32_bf16 v[96:99], v[32:35], v[48:51], v[96:99]
  s_waitcnt vmcnt(15)
  s_barrier
  ds_read_b64_tr_b16 v[64:65], v20 offset:8192
  s_waitcnt lgkmcnt(11)
  v_mfma_f32_16x16x32_bf16 v[128:131], v[40:43], v[48:51], v[128:131]
  ds_read_b64_tr_b16 v[66:67], v20 offset:9216
  s_waitcnt lgkmcnt(10)
  v_mfma_f32_16x16x32_bf16 v[100:103], v[32:35], v[52:55], v[100:103]
  ds_read_b64_tr_b16 v[80:81], v22 offset:0
  s_mul_i32 s46, s39, 28672
  s_add_u32 m0, s42, 73728
  s_add_u32 s46, s46, 860160
  buffer_load_dwordx4 v10, s[8:11], s46 offen lds
  v_mfma_f32_16x16x32_bf16 v[132:135], v[40:43], v[52:55], v[132:135]
  ds_read_b64_tr_b16 v[82:83], v22 offset:1024
  s_waitcnt lgkmcnt(10)
  v_mfma_f32_16x16x32_bf16 v[112:115], v[36:39], v[48:51], v[112:115]
  ds_read_b64_tr_b16 v[72:73], v20 offset:16384
  v_mfma_f32_16x16x32_bf16 v[116:119], v[36:39], v[52:55], v[116:119]
  ds_read_b64_tr_b16 v[74:75], v20 offset:17408
  s_mul_i32 s46, s39, 28672
  s_add_u32 m0, s42, 81920
  s_add_u32 s46, s46, 1204224
  buffer_load_dwordx4 v10, s[8:11], s46 offen lds
  s_waitcnt lgkmcnt(10)
  v_mfma_f32_16x16x32_bf16 v[144:147], v[44:47], v[48:51], v[144:147]
  ds_read_b64_tr_b16 v[84:85], v23 offset:0
  v_mfma_f32_16x16x32_bf16 v[148:151], v[44:47], v[52:55], v[148:151]
  ds_read_b64_tr_b16 v[86:87], v23 offset:1024
  s_waitcnt lgkmcnt(10)
  v_mfma_f32_16x16x32_bf16 v[104:107], v[32:35], v[56:59], v[104:107]
  ds_read_b64_tr_b16 v[68:69], v21 offset:8192
  s_mul_i32 s46, s39, 28672
  s_add_u32 m0, s42, 90112
  s_add_u32 s46, s46, 1261568
  buffer_load_dwordx4 v10, s[8:11], s46 offen lds
  v_mfma_f32_16x16x32_bf16 v[136:139], v[40:43], v[56:59], v[136:139]
  ds_read_b64_tr_b16 v[70:71], v21 offset:9216
  v_mfma_f32_16x16x32_bf16 v[120:123], v[36:39], v[56:59], v[120:123]
  ds_read_b64_tr_b16 v[76:77], v21 offset:16384
  v_add_u32 v26, 0, v4
  v_mfma_f32_16x16x32_bf16 v[152:155], v[44:47], v[56:59], v[152:155]
  ds_read_b64_tr_b16 v[78:79], v21 offset:17408
  v_add_u32 v27, 0, v5
  s_waitcnt lgkmcnt(12)
  v_mfma_f32_16x16x32_bf16 v[108:111], v[32:35], v[60:63], v[108:111]
  ds_read_b64_tr_b16 v[88:89], v24 offset:0
  v_add_u32 v28, 0, v6
  v_mfma_f32_16x16x32_bf16 v[140:143], v[40:43], v[60:63], v[140:143]
  ds_read_b64_tr_b16 v[90:91], v24 offset:1024
  v_add_u32 v29, 0, v7
  v_mfma_f32_16x16x32_bf16 v[124:127], v[36:39], v[60:63], v[124:127]
  ds_read_b64_tr_b16 v[92:93], v25 offset:0
  v_add_u32 v30, 0, v8
  v_mfma_f32_16x16x32_bf16 v[156:159], v[44:47], v[60:63], v[156:159]
  ds_read_b64_tr_b16 v[94:95], v25 offset:1024
  v_add_u32 v31, 0, v9
  s_waitcnt lgkmcnt(12)
  v_mfma_f32_16x16x32_bf16 v[96:99], v[64:67], v[80:83], v[96:99]
  s_waitcnt vmcnt(15)
  s_barrier
  ds_read_b64_tr_b16 v[32:33], v26 offset:8192
  s_waitcnt lgkmcnt(11)
  v_mfma_f32_16x16x32_bf16 v[128:131], v[72:75], v[80:83], v[128:131]
  ds_read_b64_tr_b16 v[34:35], v26 offset:9216
  s_waitcnt lgkmcnt(10)
  v_mfma_f32_16x16x32_bf16 v[100:103], v[64:67], v[84:87], v[100:103]
  ds_read_b64_tr_b16 v[48:49], v28 offset:0
  s_mul_i32 s46, s39, 28672
  s_add_u32 m0, s42, 98304
  s_add_u32 s46, s46, 1032192
  buffer_load_dwordx4 v10, s[8:11], s46 offen lds
  v_mfma_f32_16x16x32_bf16 v[132:135], v[72:75], v[84:87], v[132:135]
  ds_read_b64_tr_b16 v[50:51], v28 offset:1024
  s_waitcnt lgkmcnt(10)
  v_mfma_f32_16x16x32_bf16 v[112:115], v[68:71], v[80:83], v[112:115]
  ds_read_b64_tr_b16 v[40:41], v26 offset:16384
  v_mfma_f32_16x16x32_bf16 v[116:119], v[68:71], v[84:87], v[116:119]
  ds_read_b64_tr_b16 v[42:43], v26 offset:17408
  s_mul_i32 s46, s39, 28672
  s_add_u32 m0, s42, 106496
  s_add_u32 s46, s46, 1089536
  buffer_load_dwordx4 v10, s[8:11], s46 offen lds
  s_waitcnt lgkmcnt(10)
  v_mfma_f32_16x16x32_bf16 v[144:147], v[76:79], v[80:83], v[144:147]
  ds_read_b64_tr_b16 v[52:53], v29 offset:0
  v_mfma_f32_16x16x32_bf16 v[148:151], v[76:79], v[84:87], v[148:151]
  ds_read_b64_tr_b16 v[54:55], v29 offset:1024
  s_waitcnt lgkmcnt(10)
  v_mfma_f32_16x16x32_bf16 v[104:107], v[64:67], v[88:91], v[104:107]
  ds_read_b64_tr_b16 v[36:37], v27 offset:8192
  s_mul_i32 s46, s39, 28672
  s_add_u32 m0, s42, 114688
  s_add_u32 s46, s46, 1146880
  buffer_load_dwordx4 v10, s[8:11], s46 offen lds
  v_mfma_f32_16x16x32_bf16 v[136:139], v[72:75], v[88:91], v[136:139]
  ds_read_b64_tr_b16 v[38:39], v27 offset:9216
  v_mfma_f32_16x16x32_bf16 v[120:123], v[68:71], v[88:91], v[120:123]
  ds_read_b64_tr_b16 v[44:45], v27 offset:16384
  v_add_u32 v20, 24576, v4
  v_mfma_f32_16x16x32_bf16 v[152:155], v[76:79], v[88:91], v[152:155]
  ds_read_b64_tr_b16 v[46:47], v27 offset:17408
  v_and_b32 v11, 15, v1
  s_lshl_b32 s40, s36, 7
  s_lshl_b32 s41, s39, 6
  s_add_u32 s40, s40, s41
  v_add_u32 v11, s40, v11
  v_lshlrev_b32 v11, 3, v11
  v_add_u32 v11, 32768, v11
  v_add_u32 v21, 24576, v5
  s_waitcnt lgkmcnt(12)
  v_mfma_f32_16x16x32_bf16 v[108:111], v[64:67], v[92:95], v[108:111]
  ds_read_b64_tr_b16 v[56:57], v30 offset:0
  v_add_u32 v22, 24576, v6
  v_mfma_f32_16x16x32_bf16 v[140:143], v[72:75], v[92:95], v[140:143]
  ds_read_b64_tr_b16 v[58:59], v30 offset:1024
  v_add_u32 v23, 24576, v7
  v_mfma_f32_16x16x32_bf16 v[124:127], v[68:71], v[92:95], v[124:127]
  ds_read_b64_tr_b16 v[60:61], v31 offset:0
  v_add_u32 v24, 24576, v8
  v_mfma_f32_16x16x32_bf16 v[156:159], v[76:79], v[92:95], v[156:159]
  ds_read_b64_tr_b16 v[62:63], v31 offset:1024
  v_add_u32 v25, 24576, v9
  s_waitcnt lgkmcnt(12)
  v_mfma_f32_16x16x32_bf16 v[96:99], v[32:35], v[48:51], v[96:99]
  s_waitcnt vmcnt(13)
  s_barrier
  ds_read_b64_tr_b16 v[64:65], v20 offset:8192
  s_waitcnt lgkmcnt(11)
  v_mfma_f32_16x16x32_bf16 v[128:131], v[40:43], v[48:51], v[128:131]
  ds_read_b64_tr_b16 v[66:67], v20 offset:9216
  s_waitcnt lgkmcnt(10)
  v_mfma_f32_16x16x32_bf16 v[100:103], v[32:35], v[52:55], v[100:103]
  ds_read_b64_tr_b16 v[80:81], v22 offset:0
  s_mul_i32 s46, s39, 28672
  s_add_u32 m0, s42, 122880
  s_add_u32 s46, s46, 1318912
  buffer_load_dwordx4 v10, s[8:11], s46 offen lds
  v_mfma_f32_16x16x32_bf16 v[132:135], v[40:43], v[52:55], v[132:135]
  ds_read_b64_tr_b16 v[82:83], v22 offset:1024
  s_waitcnt lgkmcnt(10)
  v_mfma_f32_16x16x32_bf16 v[112:115], v[36:39], v[48:51], v[112:115]
  ds_read_b64_tr_b16 v[72:73], v20 offset:16384
  v_mfma_f32_16x16x32_bf16 v[116:119], v[36:39], v[52:55], v[116:119]
  ds_read_b64_tr_b16 v[74:75], v20 offset:17408
  s_mul_i32 s46, s39, 28672
  s_add_u32 m0, s42, 131072
  s_add_u32 s46, s46, 1376256
  buffer_load_dwordx4 v10, s[8:11], s46 offen lds
  s_waitcnt lgkmcnt(10)
  v_mfma_f32_16x16x32_bf16 v[144:147], v[44:47], v[48:51], v[144:147]
  ds_read_b64_tr_b16 v[84:85], v23 offset:0
  v_mfma_f32_16x16x32_bf16 v[148:151], v[44:47], v[52:55], v[148:151]
  ds_read_b64_tr_b16 v[86:87], v23 offset:1024
  s_waitcnt lgkmcnt(10)
  v_mfma_f32_16x16x32_bf16 v[104:107], v[32:35], v[56:59], v[104:107]
  ds_read_b64_tr_b16 v[68:69], v21 offset:8192
  s_mul_i32 s46, s39, 28672
  s_add_u32 m0, s42, 139264
  s_add_u32 s46, s46, 1433600
  buffer_load_dwordx4 v10, s[8:11], s46 offen lds
  v_mfma_f32_16x16x32_bf16 v[136:139], v[40:43], v[56:59], v[136:139]
  ds_read_b64_tr_b16 v[70:71], v21 offset:9216
  v_mfma_f32_16x16x32_bf16 v[120:123], v[36:39], v[56:59], v[120:123]
  ds_read_b64_tr_b16 v[76:77], v21 offset:16384
  v_mfma_f32_16x16x32_bf16 v[152:155], v[44:47], v[56:59], v[152:155]
  ds_read_b64_tr_b16 v[78:79], v21 offset:17408
  global_load_dwordx2 v[176:177], v11, s[12:13] offset:0 sc1
  global_load_dwordx2 v[178:179], v11, s[12:13] offset:128 sc1
  global_load_dwordx2 v[180:181], v11, s[12:13] offset:256 sc1
  global_load_dwordx2 v[182:183], v11, s[12:13] offset:384 sc1
  s_waitcnt lgkmcnt(12)
  v_mfma_f32_16x16x32_bf16 v[108:111], v[32:35], v[60:63], v[108:111]
  ds_read_b64_tr_b16 v[88:89], v24 offset:0
  v_mfma_f32_16x16x32_bf16 v[140:143], v[40:43], v[60:63], v[140:143]
  ds_read_b64_tr_b16 v[90:91], v24 offset:1024
  v_mfma_f32_16x16x32_bf16 v[124:127], v[36:39], v[60:63], v[124:127]
  ds_read_b64_tr_b16 v[92:93], v25 offset:0
  v_mfma_f32_16x16x32_bf16 v[156:159], v[44:47], v[60:63], v[156:159]
  ds_read_b64_tr_b16 v[94:95], v25 offset:1024
  s_waitcnt lgkmcnt(12)
  v_mfma_f32_16x16x32_bf16 v[96:99], v[64:67], v[80:83], v[96:99]
  s_barrier
  s_waitcnt lgkmcnt(10)
  v_mfma_f32_16x16x32_bf16 v[128:131], v[72:75], v[80:83], v[128:131]
  s_waitcnt lgkmcnt(8)
  v_mfma_f32_16x16x32_bf16 v[100:103], v[64:67], v[84:87], v[100:103]
  s_mul_i32 s46, s39, 28672
  s_add_u32 m0, s42, 0
  s_add_u32 s46, s46, 114688
  buffer_load_dwordx4 v10, s[8:11], s46 offen lds
  v_mfma_f32_16x16x32_bf16 v[132:135], v[72:75], v[84:87], v[132:135]
  s_waitcnt lgkmcnt(6)
  v_mfma_f32_16x16x32_bf16 v[112:115], v[68:71], v[80:83], v[112:115]
  v_mfma_f32_16x16x32_bf16 v[116:119], v[68:71], v[84:87], v[116:119]
  s_mul_i32 s46, s39, 28672
  s_add_u32 m0, s42, 8192
  s_add_u32 s46, s46, 172032
  buffer_load_dwordx4 v10, s[8:11], s46 offen lds
  s_waitcnt lgkmcnt(4)
  v_mfma_f32_16x16x32_bf16 v[144:147], v[76:79], v[80:83], v[144:147]
  v_mfma_f32_16x16x32_bf16 v[148:151], v[76:79], v[84:87], v[148:151]
  s_waitcnt lgkmcnt(2)
  v_mfma_f32_16x16x32_bf16 v[104:107], v[64:67], v[88:91], v[104:107]
  s_mul_i32 s46, s39, 28672
  s_add_u32 m0, s42, 16384
  s_add_u32 s46, s46, 229376
  buffer_load_dwordx4 v10, s[8:11], s46 offen lds
  v_mfma_f32_16x16x32_bf16 v[136:139], v[72:75], v[88:91], v[136:139]
  v_mfma_f32_16x16x32_bf16 v[120:123], v[68:71], v[88:91], v[120:123]
  v_mfma_f32_16x16x32_bf16 v[152:155], v[76:79], v[88:91], v[152:155]
  s_waitcnt lgkmcnt(0)
  v_mfma_f32_16x16x32_bf16 v[108:111], v[64:67], v[92:95], v[108:111]
  v_mfma_f32_16x16x32_bf16 v[140:143], v[72:75], v[92:95], v[140:143]
  v_mfma_f32_16x16x32_bf16 v[124:127], v[68:71], v[92:95], v[124:127]
  v_mfma_f32_16x16x32_bf16 v[156:159], v[76:79], v[92:95], v[156:159]
  s_waitcnt vmcnt(3)
  s_mov_b32 s58, 0
L_kallg_poll:
  v_max_u32 v184, v176, v177
  v_max3_u32 v184, v184, v178, v179
  v_max3_u32 v184, v184, v180, v181
  v_max3_u32 v184, v184, v182, v183
  v_max3_u32 v184, v184, v160, v161
  v_max3_u32 v184, v184, v162, v163
  v_max3_u32 v184, v184, v164, v165
  v_max3_u32 v184, v184, v166, v167
  v_max3_u32 v184, v184, v168, v169
  v_max3_u32 v184, v184, v170, v171
  v_max3_u32 v184, v184, v172, v173
  v_max3_u32 v184, v184, v174, v175
  v_cmp_eq_u32 vcc, -1, v184
  s_add_u32 s58, s58, 1
  s_cmp_ge_u32 s58, 0x40000
  s_cbranch_scc1 L_kallg_got
  s_cbranch_vccz L_kallg_got
  s_sleep 2
  global_load_dwordx2 v[176:177], v11, s[12:13] sc1
  global_load_dwordx2 v[178:179], v11, s[12:13] offset:128 sc1
  global_load_dwordx2 v[180:181], v11, s[12:13] offset:256 sc1
  global_load_dwordx2 v[182:183], v11, s[12:13] offset:384 sc1
  global_load_dwordx4 v[160:163], v16, s[12:13] sc1
  global_load_dwordx4 v[164:167], v17, s[12:13] sc1
  global_load_dwordx4 v[168:171], v18, s[12:13] sc1
  global_load_dwordx4 v[172:175], v19, s[12:13] sc1
  s_waitcnt vmcnt(0)
  s_branch L_kallg_poll
L_kallg_got:
  s_mov_b32 s40, 0xbfb8aa3b
  v_mul_f32 v184, s40, v177
  v_mul_f32 v192, -v177, v176
  v_mul_f32 v185, -v184, v176
  v_mul_f32 v186, s40, v179
  v_mul_f32 v194, -v179, v178
  v_mul_f32 v187, -v186, v178
  v_mul_f32 v188, s40, v181
  v_mul_f32 v196, -v181, v180
  v_mul_f32 v189, -v188, v180
  v_mul_f32 v190, s40, v183
  v_mul_f32 v198, -v183, v182
  v_mul_f32 v191, -v190, v182
  s_lshl_b32 s40, s36, 3
  s_lshl_b32 s41, s39, 2
  s_add_u32 s40, s40, s41
  s_mul_i32 s40, s40, 56
  s_lshl_b32 s41, s37, 2
  s_add_u32 s40, s40, s41
  s_add_u32 s40, s40, s38
  s_lshl_b32 s40, s40, 10
  v_lshl_add_u32 v11, v1, 4, s40
  s_mov_b32 s41, 0
  v_pk_mul_f32 v[96:97], v[96:97], v[184:185] op_sel_hi:[1,0]
  v_pk_mul_f32 v[128:129], v[128:129], v[176:177] op_sel:[0,1] op_sel_hi:[1,1]
  v_pk_mul_f32 v[98:99], v[98:99], v[184:185] op_sel_hi:[1,0]
  v_pk_mul_f32 v[130:131], v[130:131], v[176:177] op_sel:[0,1] op_sel_hi:[1,1]
  v_pk_mul_f32 v[112:113], v[112:113], v[184:185] op_sel_hi:[1,0]
  v_pk_mul_f32 v[144:145], v[144:145], v[176:177] op_sel:[0,1] op_sel_hi:[1,1]
  v_pk_mul_f32 v[114:115], v[114:115], v[184:185] op_sel_hi:[1,0]
  v_pk_mul_f32 v[146:147], v[146:147], v[176:177] op_sel:[0,1] op_sel_hi:[1,1]
  v_pk_fma_f32 v[96:97], v[160:161], v[184:185], v[96:97] op_sel:[0,1,0] op_sel_hi:[1,1,1]
  v_pk_fma_f32 v[128:129], v[168:169], v[192:193], v[128:129] op_sel_hi:[1,0,1]
  v_pk_fma_f32 v[98:99], v[162:163], v[184:185], v[98:99] op_sel:[0,1,0] op_sel_hi:[1,1,1]
  v_pk_fma_f32 v[130:131], v[170:171], v[192:193], v[130:131] op_sel_hi:[1,0,1]
  v_pk_fma_f32 v[112:113], v[164:165], v[184:185], v[112:113] op_sel:[0,1,0] op_sel_hi:[1,1,1]
  v_pk_fma_f32 v[144:145], v[172:173], v[192:193], v[144:145] op_sel_hi:[1,0,1]
  v_pk_fma_f32 v[114:115], v[166:167], v[184:185], v[114:115] op_sel:[0,1,0] op_sel_hi:[1,1,1]
  v_pk_fma_f32 v[146:147], v[174:175], v[192:193], v[146:147] op_sel_hi:[1,0,1]
  v_exp_f32 v96, v96
  v_exp_f32 v97, v97
  v_exp_f32 v98, v98
  v_exp_f32 v99, v99
  v_exp_f32 v112, v112
  v_exp_f32 v113, v113
  v_exp_f32 v114, v114
  v_exp_f32 v115, v115
  v_pk_add_f32 v[96:97], v[96:97], 1.0 op_sel_hi:[1,0]
  v_pk_add_f32 v[98:99], v[98:99], 1.0 op_sel_hi:[1,0]
  v_pk_add_f32 v[112:113], v[112:113], 1.0 op_sel_hi:[1,0]
  v_pk_add_f32 v[114:115], v[114:115], 1.0 op_sel_hi:[1,0]
  v_rcp_f32 v96, v96
  v_rcp_f32 v97, v97
  v_rcp_f32 v98, v98
  v_rcp_f32 v99, v99
  v_rcp_f32 v112, v112
  v_rcp_f32 v113, v113
  v_rcp_f32 v114, v114
  v_rcp_f32 v115, v115
  v_pk_mul_f32 v[128:129], v[128:129], v[96:97]
  v_pk_mul_f32 v[130:131], v[130:131], v[98:99]
  v_pk_mul_f32 v[144:145], v[144:145], v[112:113]
  v_pk_mul_f32 v[146:147], v[146:147], v[114:115]
  v_cvt_pk_bf16_f32 v200, v128, v129
  v_cvt_pk_bf16_f32 v201, v130, v131
  v_cvt_pk_bf16_f32 v202, v144, v145
  v_cvt_pk_bf16_f32 v203, v146, v147
  buffer_store_dwordx4 v[200:203], v11, s[28:31], s41 offen sc1
  s_add_u32 s41, s41, 57344
  v_pk_mul_f32 v[100:101], v[100:101], v[186:187] op_sel_hi:[1,0]
  v_pk_mul_f32 v[132:133], v[132:133], v[178:179] op_sel:[0,1] op_sel_hi:[1,1]
  v_pk_mul_f32 v[102:103], v[102:103], v[186:187] op_sel_hi:[1,0]
  v_pk_mul_f32 v[134:135], v[134:135], v[178:179] op_sel:[0,1] op_sel_hi:[1,1]
  v_pk_mul_f32 v[116:117], v[116:117], v[186:187] op_sel_hi:[1,0]
  v_pk_mul_f32 v[148:149], v[148:149], v[178:179] op_sel:[0,1] op_sel_hi:[1,1]
  v_pk_mul_f32 v[118:119], v[118:119], v[186:187] op_sel_hi:[1,0]
  v_pk_mul_f32 v[150:151], v[150:151], v[178:179] op_sel:[0,1] op_sel_hi:[1,1]
  v_pk_fma_f32 v[100:101], v[160:161], v[186:187], v[100:101] op_sel:[0,1,0] op_sel_hi:[1,1,1]
  v_pk_fma_f32 v[132:133], v[168:169], v[194:195], v[132:133] op_sel_hi:[1,0,1]
  v_pk_fma_f32 v[102:103], v[162:163], v[186:187], v[102:103] op_sel:[0,1,0] op_sel_hi:[1,1,1]
  v_pk_fma_f32 v[134:135], v[170:171], v[194:195], v[134:135] op_sel_hi:[1,0,1]
  v_pk_fma_f32 v[116:117], v[164:165], v[186:187], v[116:117] op_sel:[0,1,0] op_sel_hi:[1,1,1]
  v_pk_fma_f32 v[148:149], v[172:173], v[194:195], v[148:149] op_sel_hi:[1,0,1]
  v_pk_fma_f32 v[118:119], v[166:167], v[186:187], v[118:119] op_sel:[0,1,0] op_sel_hi:[1,1,1]
  v_pk_fma_f32 v[150:151], v[174:175], v[194:195], v[150:151] op_sel_hi:[1,0,1]
  v_exp_f32 v100, v100
  v_exp_f32 v101, v101
  v_exp_f32 v102, v102
  v_exp_f32 v103, v103
  v_exp_f32 v116, v116
  v_exp_f32 v117, v117
  v_exp_f32 v118, v118
  v_exp_f32 v119, v119
  v_pk_add_f32 v[100:101], v[100:101], 1.0 op_sel_hi:[1,0]
  v_pk_add_f32 v[102:103], v[102:103], 1.0 op_sel_hi:[1,0]
  v_pk_add_f32 v[116:117], v[116:117], 1.0 op_sel_hi:[1,0]
  v_pk_add_f32 v[118:119], v[118:119], 1.0 op_sel_hi:[1,0]
  v_rcp_f32 v100, v100
  v_rcp_f32 v101, v101
  v_rcp_f32 v102, v102
  v_rcp_f32 v103, v103
  v_rcp_f32 v116, v116
  v_rcp_f32 v117, v117
  v_rcp_f32 v118, v118
  v_rcp_f32 v119, v119
  v_pk_mul_f32 v[132:133], v[132:133], v[100:101]
  v_pk_mul_f32 v[134:135], v[134:135], v[102:103]
  v_pk_mul_f32 v[148:149], v[148:149], v[116:117]
  v_pk_mul_f32 v[150:151], v[150:151], v[118:119]
  v_cvt_pk_bf16_f32 v204, v132, v133
  v_cvt_pk_bf16_f32 v205, v134, v135
  v_cvt_pk_bf16_f32 v206, v148, v149
  v_cvt_pk_bf16_f32 v207, v150, v151
  buffer_store_dwordx4 v[204:207], v11, s[28:31], s41 offen sc1
  s_add_u32 s41, s41, 57344
  v_pk_mul_f32 v[104:105], v[104:105], v[188:189] op_sel_hi:[1,0]
  v_pk_mul_f32 v[136:137], v[136:137], v[180:181] op_sel:[0,1] op_sel_hi:[1,1]
  v_pk_mul_f32 v[106:107], v[106:107], v[188:189] op_sel_hi:[1,0]
  v_pk_mul_f32 v[138:139], v[138:139], v[180:181] op_sel:[0,1] op_sel_hi:[1,1]
  v_pk_mul_f32 v[120:121], v[120:121], v[188:189] op_sel_hi:[1,0]
  v_pk_mul_f32 v[152:153], v[152:153], v[180:181] op_sel:[0,1] op_sel_hi:[1,1]
  v_pk_mul_f32 v[122:123], v[122:123], v[188:189] op_sel_hi:[1,0]
  v_pk_mul_f32 v[154:155], v[154:155], v[180:181] op_sel:[0,1] op_sel_hi:[1,1]
  v_pk_fma_f32 v[104:105], v[160:161], v[188:189], v[104:105] op_sel:[0,1,0] op_sel_hi:[1,1,1]
  v_pk_fma_f32 v[136:137], v[168:169], v[196:197], v[136:137] op_sel_hi:[1,0,1]
  v_pk_fma_f32 v[106:107], v[162:163], v[188:189], v[106:107] op_sel:[0,1,0] op_sel_hi:[1,1,1]
  v_pk_fma_f32 v[138:139], v[170:171], v[196:197], v[138:139] op_sel_hi:[1,0,1]
  v_pk_fma_f32 v[120:121], v[164:165], v[188:189], v[120:121] op_sel:[0,1,0] op_sel_hi:[1,1,1]
  v_pk_fma_f32 v[152:153], v[172:173], v[196:197], v[152:153] op_sel_hi:[1,0,1]
  v_pk_fma_f32 v[122:123], v[166:167], v[188:189], v[122:123] op_sel:[0,1,0] op_sel_hi:[1,1,1]
  v_pk_fma_f32 v[154:155], v[174:175], v[196:197], v[154:155] op_sel_hi:[1,0,1]
  v_exp_f32 v104, v104
  v_exp_f32 v105, v105
  v_exp_f32 v106, v106
  v_exp_f32 v107, v107
  v_exp_f32 v120, v120
  v_exp_f32 v121, v121
  v_exp_f32 v122, v122
  v_exp_f32 v123, v123
  v_pk_add_f32 v[104:105], v[104:105], 1.0 op_sel_hi:[1,0]
  v_pk_add_f32 v[106:107], v[106:107], 1.0 op_sel_hi:[1,0]
  v_pk_add_f32 v[120:121], v[120:121], 1.0 op_sel_hi:[1,0]
  v_pk_add_f32 v[122:123], v[122:123], 1.0 op_sel_hi:[1,0]
  v_rcp_f32 v104, v104
  v_rcp_f32 v105, v105
  v_rcp_f32 v106, v106
  v_rcp_f32 v107, v107
  v_rcp_f32 v120, v120
  v_rcp_f32 v121, v121
  v_rcp_f32 v122, v122
  v_rcp_f32 v123, v123
  v_pk_mul_f32 v[136:137], v[136:137], v[104:105]
  v_pk_mul_f32 v[138:139], v[138:139], v[106:107]
  v_pk_mul_f32 v[152:153], v[152:153], v[120:121]
  v_pk_mul_f32 v[154:155], v[154:155], v[122:123]
  v_cvt_pk_bf16_f32 v208, v136, v137
  v_cvt_pk_bf16_f32 v209, v138, v139
  v_cvt_pk_bf16_f32 v210, v152, v153
  v_cvt_pk_bf16_f32 v211, v154, v155
  buffer_store_dwordx4 v[208:211], v11, s[28:31], s41 offen sc1
  s_add_u32 s41, s41, 57344
  v_pk_mul_f32 v[108:109], v[108:109], v[190:191] op_sel_hi:[1,0]
  v_pk_mul_f32 v[140:141], v[140:141], v[182:183] op_sel:[0,1] op_sel_hi:[1,1]
  v_pk_mul_f32 v[110:111], v[110:111], v[190:191] op_sel_hi:[1,0]
  v_pk_mul_f32 v[142:143], v[142:143], v[182:183] op_sel:[0,1] op_sel_hi:[1,1]
  v_pk_mul_f32 v[124:125], v[124:125], v[190:191] op_sel_hi:[1,0]
  v_pk_mul_f32 v[156:157], v[156:157], v[182:183] op_sel:[0,1] op_sel_hi:[1,1]
  v_pk_mul_f32 v[126:127], v[126:127], v[190:191] op_sel_hi:[1,0]
  v_pk_mul_f32 v[158:159], v[158:159], v[182:183] op_sel:[0,1] op_sel_hi:[1,1]
  v_pk_fma_f32 v[108:109], v[160:161], v[190:191], v[108:109] op_sel:[0,1,0] op_sel_hi:[1,1,1]
  v_pk_fma_f32 v[140:141], v[168:169], v[198:199], v[140:141] op_sel_hi:[1,0,1]
  v_pk_fma_f32 v[110:111], v[162:163], v[190:191], v[110:111] op_sel:[0,1,0] op_sel_hi:[1,1,1]
  v_pk_fma_f32 v[142:143], v[170:171], v[198:199], v[142:143] op_sel_hi:[1,0,1]
  v_pk_fma_f32 v[124:125], v[164:165], v[190:191], v[124:125] op_sel:[0,1,0] op_sel_hi:[1,1,1]
  v_pk_fma_f32 v[156:157], v[172:173], v[198:199], v[156:157] op_sel_hi:[1,0,1]
  v_pk_fma_f32 v[126:127], v[166:167], v[190:191], v[126:127] op_sel:[0,1,0] op_sel_hi:[1,1,1]
  v_pk_fma_f32 v[158:159], v[174:175], v[198:199], v[158:159] op_sel_hi:[1,0,1]
  v_exp_f32 v108, v108
  v_exp_f32 v109, v109
  v_exp_f32 v110, v110
  v_exp_f32 v111, v111
  v_exp_f32 v124, v124
  v_exp_f32 v125, v125
  v_exp_f32 v126, v126
  v_exp_f32 v127, v127
  v_pk_add_f32 v[108:109], v[108:109], 1.0 op_sel_hi:[1,0]
  v_pk_add_f32 v[110:111], v[110:111], 1.0 op_sel_hi:[1,0]
  v_pk_add_f32 v[124:125], v[124:125], 1.0 op_sel_hi:[1,0]
  v_pk_add_f32 v[126:127], v[126:127], 1.0 op_sel_hi:[1,0]
  v_rcp_f32 v108, v108
  v_rcp_f32 v109, v109
  v_rcp_f32 v110, v110
  v_rcp_f32 v111, v111
  v_rcp_f32 v124, v124
  v_rcp_f32 v125, v125
  v_rcp_f32 v126, v126
  v_rcp_f32 v127, v127
  v_pk_mul_f32 v[140:141], v[140:141], v[108:109]
  v_pk_mul_f32 v[142:143], v[142:143], v[110:111]
  v_pk_mul_f32 v[156:157], v[156:157], v[124:125]
  v_pk_mul_f32 v[158:159], v[158:159], v[126:127]
  v_cvt_pk_bf16_f32 v212, v140, v141
  v_cvt_pk_bf16_f32 v213, v142, v143
  v_cvt_pk_bf16_f32 v214, v156, v157
  v_cvt_pk_bf16_f32 v215, v158, v159
  buffer_store_dwordx4 v[212:215], v11, s[28:31], s41 offen sc1
  s_add_u32 s41, s41, 57344
  s_waitcnt vmcnt(17)
  s_barrier
  s_mul_i32 s46, s39, 28672
  s_add_u32 m0, s42, 24576
  s_add_u32 s46, s46, 286720
  buffer_load_dwordx4 v10, s[8:11], s46 offen lds
  s_mul_i32 s46, s39, 28672
  s_add_u32 m0, s42, 32768
  s_add_u32 s46, s46, 344064
  buffer_load_dwordx4 v10, s[8:11], s46 offen lds
  s_mul_i32 s46, s39, 28672
  s_add_u32 m0, s42, 40960
  s_add_u32 s46, s46, 516096
  buffer_load_dwordx4 v10, s[8:11], s46 offen lds
  v_lshrrev_b32 v14, 4, v1
  v_bfe_u32 v15, v1, 2, 2
  v_lshl_add_u32 v12, v14, 2, v15
  v_lshlrev_b32 v12, 7, v12
  v_and_b32 v13, 3, v1
  v_lshl_add_u32 v12, v13, 3, v12
  v_and_b32 v14, 1, v14
  v_lshrrev_b32 v15, 1, v15
  v_lshl_or_b32 v15, v14, 1, v15
  v_xor_b32 v15, s38, v15
  s_lshl_b32 s40, s38, 2
  s_add_u32 s40, s40, 8
  s_lshl_b32 s40, s40, 12
  s_cmp_eq_u32 s38, 0
  s_cselect_b32 s40, 147456, s40
  s_mul_i32 s41, s38, 40960
  v_xor_b32 v13, 0, v15
  v_lshl_add_u32 v13, v13, 5, v12
  v_add_u32 v20, s40, v13
  v_add_u32 v24, s41, v13
  v_xor_b32 v13, 1, v15
  v_lshl_add_u32 v13, v13, 5, v12
  v_add_u32 v21, s40, v13
  v_add_u32 v25, s41, v13
  v_xor_b32 v13, 2, v15
  v_lshl_add_u32 v13, v13, 5, v12
  v_add_u32 v22, s40, v13
  v_add_u32 v26, s41, v13
  v_xor_b32 v13, 3, v15
  v_lshl_add_u32 v13, v13, 5, v12
  v_add_u32 v23, s40, v13
  v_add_u32 v27, s41, v13
  ds_read_b64_tr_b16 v[32:33], v20 offset:0
  ds_read_b64_tr_b16 v[34:35], v20 offset:2048
  ds_read_b64_tr_b16 v[36:37], v21 offset:0
  ds_read_b64_tr_b16 v[38:39], v21 offset:2048
  ds_read_b64_tr_b16 v[40:41], v22 offset:0
  ds_read_b64_tr_b16 v[42:43], v22 offset:2048
  ds_read_b64_tr_b16 v[44:45], v23 offset:0
  ds_read_b64_tr_b16 v[46:47], v23 offset:2048
  ds_read_b64_tr_b16 v[48:49], v20 offset:4096
  ds_read_b64_tr_b16 v[50:51], v20 offset:6144
  ds_read_b64_tr_b16 v[52:53], v21 offset:4096
  ds_read_b64_tr_b16 v[54:55], v21 offset:6144
  ds_read_b64_tr_b16 v[56:57], v22 offset:4096
  ds_read_b64_tr_b16 v[58:59], v22 offset:6144
  ds_read_b64_tr_b16 v[60:61], v23 offset:4096
  ds_read_b64_tr_b16 v[62:63], v23 offset:6144
  ds_read_b64_tr_b16 v[64:65], v20 offset:8192
  ds_read_b64_tr_b16 v[66:67], v20 offset:10240
  ds_read_b64_tr_b16 v[68:69], v21 offset:8192
  ds_read_b64_tr_b16 v[70:71], v21 offset:10240
  ds_read_b64_tr_b16 v[72:73], v22 offset:8192
  ds_read_b64_tr_b16 v[74:75], v22 offset:10240
  ds_read_b64_tr_b16 v[76:77], v23 offset:8192
  ds_read_b64_tr_b16 v[78:79], v23 offset:10240
  ds_read_b64_tr_b16 v[80:81], v20 offset:12288
  ds_read_b64_tr_b16 v[82:83], v20 offset:14336
  ds_read_b64_tr_b16 v[84:85], v21 offset:12288
  ds_read_b64_tr_b16 v[86:87], v21 offset:14336
  ds_read_b64_tr_b16 v[88:89], v22 offset:12288
  ds_read_b64_tr_b16 v[90:91], v22 offset:14336
  ds_read_b64_tr_b16 v[92:93], v23 offset:12288
  ds_read_b64_tr_b16 v[94:95], v23 offset:14336
  s_lshl_b32 s40, s36, 1
  s_add_u32 s40, s40, s59
  s_lshl_b32 s41, s40, 2
  s_lshl_b32 s43, s39, 1
  s_add_u32 s41, s41, s43
  s_mul_i32 s43, s41, 56
  s_mul_i32 s44, s38, 14
  s_add_u32 s43, s43, s44
  s_lshl_b32 s43, s43, 10
  v_lshl_add_u32 v2, v1, 4, s43
  v_add_u32 v3, 57344, v2
  v_and_b32 v4, 15, v1
  s_lshl_b32 s41, s41, 4
  v_add_u32 v4, s41, v4
  s_lshl_b32 s43, s60, 6
  s_lshl_b32 s44, s38, 4
  s_add_u32 s43, s43, s44
  v_lshrrev_b32 v5, 4, v1
  v_lshlrev_b32 v6, 2, v5
  v_add_u32 v6, s43, v6
  v_lshlrev_b32 v6, 12, v6
  v_lshl_add_u32 v6, v4, 1, v6
  v_and_b32 v7, 1, v5
  v_lshl_add_u32 v4, v7, 4, v4
  s_movk_i32 s44, 896
  v_mul_lo_u32 v4, v4, s44
  v_lshrrev_b32 v5, 1, v5
  v_lshlrev_b32 v5, 4, v5
  s_lshl_b32 s43, s43, 1
  v_add3_u32 v7, v4, v5, s43
  s_lshl_b32 s40, s36, 7
  s_add_u32 s40, s40, 49152
  v_mov_b32 v8, s40
  s_waitcnt vmcnt(3) lgkmcnt(0)
  s_barrier
  s_cmp_lg_u32 s33, 0
  s_cbranch_scc1 L_kallg_noarr
  v_mov_b32 v9, 1
  s_mov_b64 s[56:57], exec
  s_mov_b64 exec, 1
  global_atomic_add v8, v9, s[12:13] sc1
  s_mov_b64 exec, s[56:57]
L_kallg_noarr:
  s_mul_i32 s46, s39, 28672
  s_add_u32 m0, s42, 49152
  s_add_u32 s46, s46, 573440
  buffer_load_dwordx4 v10, s[8:11], s46 offen lds
  s_mul_i32 s46, s39, 28672
  s_add_u32 m0, s42, 57344
  s_add_u32 s46, s46, 630784
  buffer_load_dwordx4 v10, s[8:11], s46 offen lds
  s_mul_i32 s46, s39, 28672
  s_add_u32 m0, s42, 65536
  s_add_u32 s46, s46, 688128
  buffer_load_dwordx4 v10, s[8:11], s46 offen lds
  s_mul_i32 s46, s39, 28672
  s_add_u32 m0, s42, 73728
  s_add_u32 s46, s46, 745472
  buffer_load_dwordx4 v10, s[8:11], s46 offen lds
  s_mul_i32 s46, s39, 28672
  s_add_u32 m0, s42, 81920
  s_add_u32 s46, s46, 917504
  buffer_load_dwordx4 v10, s[8:11], s46 offen lds
  s_mul_i32 s46, s39, 28672
  s_add_u32 m0, s42, 90112
  s_add_u32 s46, s46, 974848
  buffer_load_dwordx4 v10, s[8:11], s46 offen lds
  s_mul_i32 s46, s39, 28672
  s_add_u32 m0, s42, 147456
  s_add_u32 s46, s46, 1490944
  buffer_load_dwordx4 v10, s[8:11], s46 offen lds
  s_mul_i32 s46, s39, 28672
  s_add_u32 m0, s42, 155648
  s_add_u32 s46, s46, 1548288
  buffer_load_dwordx4 v10, s[8:11], s46 offen lds
  s_mov_b32 s40, 0
  buffer_load_ushort v12, v6, s[16:19], s40 offen sc1
  s_mov_b32 s40, 4096
  buffer_load_ushort v13, v6, s[16:19], s40 offen sc1
  s_mov_b32 s40, 8192
  buffer_load_ushort v14, v6, s[16:19], s40 offen sc1
  s_mov_b32 s40, 12288
  buffer_load_ushort v15, v6, s[16:19], s40 offen sc1
  s_mov_b32 s40, 32
  buffer_load_ushort v16, v6, s[16:19], s40 offen sc1
  s_mov_b32 s40, 4128
  buffer_load_ushort v17, v6, s[16:19], s40 offen sc1
  s_mov_b32 s40, 8224
  buffer_load_ushort v18, v6, s[16:19], s40 offen sc1
  s_mov_b32 s40, 12320
  buffer_load_ushort v19, v6, s[16:19], s40 offen sc1
  s_cmp_lg_u32 s33, 0
  s_cbranch_scc1 L_kallg_nopoll
  s_mov_b32 s58, 0
L_kallg_poll2:
  global_load_dword v9, v8, s[12:13] sc1
  s_waitcnt vmcnt(0)
  v_readfirstlane_b32 s40, v9
  s_add_u32 s58, s58, 1
  s_cmp_ge_u32 s40, 14
  s_cbranch_scc1 L_kallg_nopoll
  s_cmp_ge_u32 s58, 0x40000
  s_cbranch_scc1 L_kallg_nopoll
  s_sleep 1
  s_branch L_kallg_poll2
L_kallg_nopoll:
  s_waitcnt vmcnt(0)
  s_barrier
  s_mov_b32 s40, 0
  buffer_load_dwordx4 v[96:99], v2, s[28:31], s40 offen sc1
  buffer_load_dwordx4 v[100:103], v3, s[28:31], s40 offen sc1
  s_mov_b32 s40, 1024
  buffer_load_dwordx4 v[104:107], v2, s[28:31], s40 offen sc1
  buffer_load_dwordx4 v[108:111], v3, s[28:31], s40 offen sc1
  s_mov_b32 s40, 2048
  buffer_load_dwordx4 v[112:115], v2, s[28:31], s40 offen sc1
  buffer_load_dwordx4 v[116:119], v3, s[28:31], s40 offen sc1
  s_waitcnt vmcnt(4)
  v_mfma_f32_16x16x32_bf16 v[208:211], v[32:35], v[96:99], 0
  v_mfma_f32_16x16x32_bf16 v[216:219], v[36:39], v[96:99], 0
  s_mov_b32 s40, 3072
  buffer_load_dwordx4 v[120:123], v2, s[28:31], s40 offen sc1
  buffer_load_dwordx4 v[124:127], v3, s[28:31], s40 offen sc1
  v_mfma_f32_16x16x32_bf16 v[224:227], v[40:43], v[96:99], 0
  v_mfma_f32_16x16x32_bf16 v[232:235], v[44:47], v[96:99], 0
  v_mfma_f32_16x16x32_bf16 v[212:215], v[32:35], v[100:103], 0
  v_mfma_f32_16x16x32_bf16 v[220:223], v[36:39], v[100:103], 0
  v_mfma_f32_16x16x32_bf16 v[228:231], v[40:43], v[100:103], 0
  v_mfma_f32_16x16x32_bf16 v[236:239], v[44:47], v[100:103], 0
  s_waitcnt vmcnt(4)
  v_mfma_f32_16x16x32_bf16 v[208:211], v[48:51], v[104:107], v[208:211]
  v_mfma_f32_16x16x32_bf16 v[216:219], v[52:55], v[104:107], v[216:219]
  s_mov_b32 s40, 4096
  buffer_load_dwordx4 v[128:131], v2, s[28:31], s40 offen sc1
  buffer_load_dwordx4 v[132:135], v3, s[28:31], s40 offen sc1
  v_mfma_f32_16x16x32_bf16 v[224:227], v[56:59], v[104:107], v[224:227]
  v_mfma_f32_16x16x32_bf16 v[232:235], v[60:63], v[104:107], v[232:235]
  v_mfma_f32_16x16x32_bf16 v[212:215], v[48:51], v[108:111], v[212:215]
  v_mfma_f32_16x16x32_bf16 v[220:223], v[52:55], v[108:111], v[220:223]
  v_mfma_f32_16x16x32_bf16 v[228:231], v[56:59], v[108:111], v[228:231]
  v_mfma_f32_16x16x32_bf16 v[236:239], v[60:63], v[108:111], v[236:239]
  s_waitcnt vmcnt(4)
  v_mfma_f32_16x16x32_bf16 v[208:211], v[64:67], v[112:115], v[208:211]
  v_mfma_f32_16x16x32_bf16 v[216:219], v[68:71], v[112:115], v[216:219]
  s_mov_b32 s40, 5120
  buffer_load_dwordx4 v[136:139], v2, s[28:31], s40 offen sc1
  buffer_load_dwordx4 v[140:143], v3, s[28:31], s40 offen sc1
  v_mfma_f32_16x16x32_bf16 v[224:227], v[72:75], v[112:115], v[224:227]
  v_mfma_f32_16x16x32_bf16 v[232:235], v[76:79], v[112:115], v[232:235]
  v_mfma_f32_16x16x32_bf16 v[212:215], v[64:67], v[116:119], v[212:215]
  v_mfma_f32_16x16x32_bf16 v[220:223], v[68:71], v[116:119], v[220:223]
  v_mfma_f32_16x16x32_bf16 v[228:231], v[72:75], v[116:119], v[228:231]
  v_mfma_f32_16x16x32_bf16 v[236:239], v[76:79], v[116:119], v[236:239]
  s_waitcnt vmcnt(4)
  v_mfma_f32_16x16x32_bf16 v[208:211], v[80:83], v[120:123], v[208:211]
  ds_read_b64_tr_b16 v[240:241], v24 offset:0
  v_mfma_f32_16x16x32_bf16 v[216:219], v[84:87], v[120:123], v[216:219]
  ds_read_b64_tr_b16 v[242:243], v24 offset:2048
  s_mov_b32 s40, 6144
  buffer_load_dwordx4 v[144:147], v2, s[28:31], s40 offen sc1
  buffer_load_dwordx4 v[148:151], v3, s[28:31], s40 offen sc1
  v_mfma_f32_16x16x32_bf16 v[224:227], v[88:91], v[120:123], v[224:227]
  ds_read_b64_tr_b16 v[244:245], v25 offset:0
  v_mfma_f32_16x16x32_bf16 v[232:235], v[92:95], v[120:123], v[232:235]
  ds_read_b64_tr_b16 v[246:247], v25 offset:2048
  v_mfma_f32_16x16x32_bf16 v[212:215], v[80:83], v[124:127], v[212:215]
  ds_read_b64_tr_b16 v[248:249], v26 offset:0
  v_mfma_f32_16x16x32_bf16 v[220:223], v[84:87], v[124:127], v[220:223]
  ds_read_b64_tr_b16 v[250:251], v26 offset:2048
  v_mfma_f32_16x16x32_bf16 v[228:231], v[88:91], v[124:127], v[228:231]
  ds_read_b64_tr_b16 v[252:253], v27 offset:0
  v_mfma_f32_16x16x32_bf16 v[236:239], v[92:95], v[124:127], v[236:239]
  ds_read_b64_tr_b16 v[254:255], v27 offset:2048
  s_waitcnt vmcnt(4) lgkmcnt(0)
  v_mfma_f32_16x16x32_bf16 v[208:211], v[240:243], v[128:131], v[208:211]
  ds_read_b64_tr_b16 v[32:33], v24 offset:4096
  v_mfma_f32_16x16x32_bf16 v[216:219], v[244:247], v[128:131], v[216:219]
  ds_read_b64_tr_b16 v[34:35], v24 offset:6144
  s_mov_b32 s40, 7168
  buffer_load_dwordx4 v[152:155], v2, s[28:31], s40 offen sc1
  buffer_load_dwordx4 v[156:159], v3, s[28:31], s40 offen sc1
  v_mfma_f32_16x16x32_bf16 v[224:227], v[248:251], v[128:131], v[224:227]
  ds_read_b64_tr_b16 v[36:37], v25 offset:4096
  v_mfma_f32_16x16x32_bf16 v[232:235], v[252:255], v[128:131], v[232:235]
  ds_read_b64_tr_b16 v[38:39], v25 offset:6144
  v_mfma_f32_16x16x32_bf16 v[212:215], v[240:243], v[132:135], v[212:215]
  ds_read_b64_tr_b16 v[40:41], v26 offset:4096
  v_mfma_f32_16x16x32_bf16 v[220:223], v[244:247], v[132:135], v[220:223]
  ds_read_b64_tr_b16 v[42:43], v26 offset:6144
  v_mfma_f32_16x16x32_bf16 v[228:231], v[248:251], v[132:135], v[228:231]
  ds_read_b64_tr_b16 v[44:45], v27 offset:4096
  v_mfma_f32_16x16x32_bf16 v[236:239], v[252:255], v[132:135], v[236:239]
  ds_read_b64_tr_b16 v[46:47], v27 offset:6144
  s_waitcnt vmcnt(4) lgkmcnt(0)
  v_mfma_f32_16x16x32_bf16 v[208:211], v[32:35], v[136:139], v[208:211]
  ds_read_b64_tr_b16 v[48:49], v24 offset:8192
  v_mfma_f32_16x16x32_bf16 v[216:219], v[36:39], v[136:139], v[216:219]
  ds_read_b64_tr_b16 v[50:51], v24 offset:10240
  s_mov_b32 s40, 8192
  buffer_load_dwordx4 v[160:163], v2, s[28:31], s40 offen sc1
  buffer_load_dwordx4 v[164:167], v3, s[28:31], s40 offen sc1
  v_mfma_f32_16x16x32_bf16 v[224:227], v[40:43], v[136:139], v[224:227]
  ds_read_b64_tr_b16 v[52:53], v25 offset:8192
  v_mfma_f32_16x16x32_bf16 v[232:235], v[44:47], v[136:139], v[232:235]
  ds_read_b64_tr_b16 v[54:55], v25 offset:10240
  v_mfma_f32_16x16x32_bf16 v[212:215], v[32:35], v[140:143], v[212:215]
  ds_read_b64_tr_b16 v[56:57], v26 offset:8192
  v_mfma_f32_16x16x32_bf16 v[220:223], v[36:39], v[140:143], v[220:223]
  ds_read_b64_tr_b16 v[58:59], v26 offset:10240
  v_mfma_f32_16x16x32_bf16 v[228:231], v[40:43], v[140:143], v[228:231]
  ds_read_b64_tr_b16 v[60:61], v27 offset:8192
  v_mfma_f32_16x16x32_bf16 v[236:239], v[44:47], v[140:143], v[236:239]
  ds_read_b64_tr_b16 v[62:63], v27 offset:10240
  s_waitcnt vmcnt(4) lgkmcnt(0)
  v_mfma_f32_16x16x32_bf16 v[208:211], v[48:51], v[144:147], v[208:211]
  ds_read_b64_tr_b16 v[32:33], v24 offset:12288
  v_mfma_f32_16x16x32_bf16 v[216:219], v[52:55], v[144:147], v[216:219]
  ds_read_b64_tr_b16 v[34:35], v24 offset:14336
  s_mov_b32 s40, 9216
  buffer_load_dwordx4 v[168:171], v2, s[28:31], s40 offen sc1
  buffer_load_dwordx4 v[172:175], v3, s[28:31], s40 offen sc1
  v_mfma_f32_16x16x32_bf16 v[224:227], v[56:59], v[144:147], v[224:227]
  ds_read_b64_tr_b16 v[36:37], v25 offset:12288
  v_mfma_f32_16x16x32_bf16 v[232:235], v[60:63], v[144:147], v[232:235]
  ds_read_b64_tr_b16 v[38:39], v25 offset:14336
  v_mfma_f32_16x16x32_bf16 v[212:215], v[48:51], v[148:151], v[212:215]
  ds_read_b64_tr_b16 v[40:41], v26 offset:12288
  v_mfma_f32_16x16x32_bf16 v[220:223], v[52:55], v[148:151], v[220:223]
  ds_read_b64_tr_b16 v[42:43], v26 offset:14336
  v_mfma_f32_16x16x32_bf16 v[228:231], v[56:59], v[148:151], v[228:231]
  ds_read_b64_tr_b16 v[44:45], v27 offset:12288
  v_mfma_f32_16x16x32_bf16 v[236:239], v[60:63], v[148:151], v[236:239]
  ds_read_b64_tr_b16 v[46:47], v27 offset:14336
  s_waitcnt vmcnt(4) lgkmcnt(0)
  v_mfma_f32_16x16x32_bf16 v[208:211], v[32:35], v[152:155], v[208:211]
  ds_read_b64_tr_b16 v[48:49], v24 offset:16384
  v_mfma_f32_16x16x32_bf16 v[216:219], v[36:39], v[152:155], v[216:219]
  ds_read_b64_tr_b16 v[50:51], v24 offset:18432
  s_mov_b32 s40, 10240
  buffer_load_dwordx4 v[176:179], v2, s[28:31], s40 offen sc1
  buffer_load_dwordx4 v[180:183], v3, s[28:31], s40 offen sc1
  v_mfma_f32_16x16x32_bf16 v[224:227], v[40:43], v[152:155], v[224:227]
  ds_read_b64_tr_b16 v[52:53], v25 offset:16384
  v_mfma_f32_16x16x32_bf16 v[232:235], v[44:47], v[152:155], v[232:235]
  ds_read_b64_tr_b16 v[54:55], v25 offset:18432
  v_mfma_f32_16x16x32_bf16 v[212:215], v[32:35], v[156:159], v[212:215]
  ds_read_b64_tr_b16 v[56:57], v26 offset:16384
  v_mfma_f32_16x16x32_bf16 v[220:223], v[36:39], v[156:159], v[220:223]
  ds_read_b64_tr_b16 v[58:59], v26 offset:18432
  v_mfma_f32_16x16x32_bf16 v[228:231], v[40:43], v[156:159], v[228:231]
  ds_read_b64_tr_b16 v[60:61], v27 offset:16384
  v_mfma_f32_16x16x32_bf16 v[236:239], v[44:47], v[156:159], v[236:239]
  ds_read_b64_tr_b16 v[62:63], v27 offset:18432
  s_waitcnt vmcnt(4) lgkmcnt(0)
  v_mfma_f32_16x16x32_bf16 v[208:211], v[48:51], v[160:163], v[208:211]
  ds_read_b64_tr_b16 v[32:33], v24 offset:20480
  v_mfma_f32_16x16x32_bf16 v[216:219], v[52:55], v[160:163], v[216:219]
  ds_read_b64_tr_b16 v[34:35], v24 offset:22528
  s_mov_b32 s40, 11264
  buffer_load_dwordx4 v[184:187], v2, s[28:31], s40 offen sc1
  buffer_load_dwordx4 v[188:191], v3, s[28:31], s40 offen sc1
  v_mfma_f32_16x16x32_bf16 v[224:227], v[56:59], v[160:163], v[224:227]
  ds_read_b64_tr_b16 v[36:37], v25 offset:20480
  v_mfma_f32_16x16x32_bf16 v[232:235], v[60:63], v[160:163], v[232:235]
  ds_read_b64_tr_b16 v[38:39], v25 offset:22528
  v_mfma_f32_16x16x32_bf16 v[212:215], v[48:51], v[164:167], v[212:215]
  ds_read_b64_tr_b16 v[40:41], v26 offset:20480
  v_mfma_f32_16x16x32_bf16 v[220:223], v[52:55], v[164:167], v[220:223]
  ds_read_b64_tr_b16 v[42:43], v26 offset:22528
  v_mfma_f32_16x16x32_bf16 v[228:231], v[56:59], v[164:167], v[228:231]
  ds_read_b64_tr_b16 v[44:45], v27 offset:20480
  v_mfma_f32_16x16x32_bf16 v[236:239], v[60:63], v[164:167], v[236:239]
  ds_read_b64_tr_b16 v[46:47], v27 offset:22528
  s_waitcnt vmcnt(4) lgkmcnt(0)
  v_mfma_f32_16x16x32_bf16 v[208:211], v[32:35], v[168:171], v[208:211]
  ds_read_b64_tr_b16 v[48:49], v24 offset:24576
  v_mfma_f32_16x16x32_bf16 v[216:219], v[36:39], v[168:171], v[216:219]
  ds_read_b64_tr_b16 v[50:51], v24 offset:26624
  s_mov_b32 s40, 12288
  buffer_load_dwordx4 v[192:195], v2, s[28:31], s40 offen sc1
  buffer_load_dwordx4 v[196:199], v3, s[28:31], s40 offen sc1
  v_mfma_f32_16x16x32_bf16 v[224:227], v[40:43], v[168:171], v[224:227]
  ds_read_b64_tr_b16 v[52:53], v25 offset:24576
  v_mfma_f32_16x16x32_bf16 v[232:235], v[44:47], v[168:171], v[232:235]
  ds_read_b64_tr_b16 v[54:55], v25 offset:26624
  v_mfma_f32_16x16x32_bf16 v[212:215], v[32:35], v[172:175], v[212:215]
  ds_read_b64_tr_b16 v[56:57], v26 offset:24576
  v_mfma_f32_16x16x32_bf16 v[220:223], v[36:39], v[172:175], v[220:223]
  ds_read_b64_tr_b16 v[58:59], v26 offset:26624
  v_mfma_f32_16x16x32_bf16 v[228:231], v[40:43], v[172:175], v[228:231]
  ds_read_b64_tr_b16 v[60:61], v27 offset:24576
  v_mfma_f32_16x16x32_bf16 v[236:239], v[44:47], v[172:175], v[236:239]
  ds_read_b64_tr_b16 v[62:63], v27 offset:26624
  s_waitcnt vmcnt(4) lgkmcnt(0)
  v_mfma_f32_16x16x32_bf16 v[208:211], v[48:51], v[176:179], v[208:211]
  ds_read_b64_tr_b16 v[32:33], v24 offset:28672
  v_mfma_f32_16x16x32_bf16 v[216:219], v[52:55], v[176:179], v[216:219]
  ds_read_b64_tr_b16 v[34:35], v24 offset:30720
  s_mov_b32 s40, 13312
  buffer_load_dwordx4 v[200:203], v2, s[28:31], s40 offen sc1
  buffer_load_dwordx4 v[204:207], v3, s[28:31], s40 offen sc1
  v_mfma_f32_16x16x32_bf16 v[224:227], v[56:59], v[176:179], v[224:227]
  ds_read_b64_tr_b16 v[36:37], v25 offset:28672
  v_mfma_f32_16x16x32_bf16 v[232:235], v[60:63], v[176:179], v[232:235]
  ds_read_b64_tr_b16 v[38:39], v25 offset:30720
  v_mfma_f32_16x16x32_bf16 v[212:215], v[48:51], v[180:183], v[212:215]
  ds_read_b64_tr_b16 v[40:41], v26 offset:28672
  v_mfma_f32_16x16x32_bf16 v[220:223], v[52:55], v[180:183], v[220:223]
  ds_read_b64_tr_b16 v[42:43], v26 offset:30720
  v_mfma_f32_16x16x32_bf16 v[228:231], v[56:59], v[180:183], v[228:231]
  ds_read_b64_tr_b16 v[44:45], v27 offset:28672
  v_mfma_f32_16x16x32_bf16 v[236:239], v[60:63], v[180:183], v[236:239]
  ds_read_b64_tr_b16 v[46:47], v27 offset:30720
  s_waitcnt vmcnt(4) lgkmcnt(0)
  v_mfma_f32_16x16x32_bf16 v[208:211], v[32:35], v[184:187], v[208:211]
  ds_read_b64_tr_b16 v[48:49], v24 offset:32768
  v_mfma_f32_16x16x32_bf16 v[216:219], v[36:39], v[184:187], v[216:219]
  ds_read_b64_tr_b16 v[50:51], v24 offset:34816
  v_mfma_f32_16x16x32_bf16 v[224:227], v[40:43], v[184:187], v[224:227]
  ds_read_b64_tr_b16 v[52:53], v25 offset:32768
  v_mfma_f32_16x16x32_bf16 v[232:235], v[44:47], v[184:187], v[232:235]
  ds_read_b64_tr_b16 v[54:55], v25 offset:34816
  v_mfma_f32_16x16x32_bf16 v[212:215], v[32:35], v[188:191], v[212:215]
  ds_read_b64_tr_b16 v[56:57], v26 offset:32768
  v_mfma_f32_16x16x32_bf16 v[220:223], v[36:39], v[188:191], v[220:223]
  ds_read_b64_tr_b16 v[58:59], v26 offset:34816
  v_mfma_f32_16x16x32_bf16 v[228:231], v[40:43], v[188:191], v[228:231]
  ds_read_b64_tr_b16 v[60:61], v27 offset:32768
  v_mfma_f32_16x16x32_bf16 v[236:239], v[44:47], v[188:191], v[236:239]
  ds_read_b64_tr_b16 v[62:63], v27 offset:34816
  s_waitcnt vmcnt(2) lgkmcnt(0)
  v_mfma_f32_16x16x32_bf16 v[208:211], v[48:51], v[192:195], v[208:211]
  ds_read_b64_tr_b16 v[32:33], v24 offset:36864
  v_mfma_f32_16x16x32_bf16 v[216:219], v[52:55], v[192:195], v[216:219]
  ds_read_b64_tr_b16 v[34:35], v24 offset:38912
  v_mfma_f32_16x16x32_bf16 v[224:227], v[56:59], v[192:195], v[224:227]
  ds_read_b64_tr_b16 v[36:37], v25 offset:36864
  v_mfma_f32_16x16x32_bf16 v[232:235], v[60:63], v[192:195], v[232:235]
  ds_read_b64_tr_b16 v[38:39], v25 offset:38912
  v_mfma_f32_16x16x32_bf16 v[212:215], v[48:51], v[196:199], v[212:215]
  ds_read_b64_tr_b16 v[40:41], v26 offset:36864
  v_mfma_f32_16x16x32_bf16 v[220:223], v[52:55], v[196:199], v[220:223]
  ds_read_b64_tr_b16 v[42:43], v26 offset:38912
  v_mfma_f32_16x16x32_bf16 v[228:231], v[56:59], v[196:199], v[228:231]
  ds_read_b64_tr_b16 v[44:45], v27 offset:36864
  v_mfma_f32_16x16x32_bf16 v[236:239], v[60:63], v[196:199], v[236:239]
  ds_read_b64_tr_b16 v[46:47], v27 offset:38912
  s_waitcnt vmcnt(0) lgkmcnt(0)
  v_mfma_f32_16x16x32_bf16 v[208:211], v[32:35], v[200:203], v[208:211]
  v_mfma_f32_16x16x32_bf16 v[216:219], v[36:39], v[200:203], v[216:219]
  v_mfma_f32_16x16x32_bf16 v[224:227], v[40:43], v[200:203], v[224:227]
  v_mfma_f32_16x16x32_bf16 v[232:235], v[44:47], v[200:203], v[232:235]
  v_mfma_f32_16x16x32_bf16 v[212:215], v[32:35], v[204:207], v[212:215]
  v_mfma_f32_16x16x32_bf16 v[220:223], v[36:39], v[204:207], v[220:223]
  v_mfma_f32_16x16x32_bf16 v[228:231], v[40:43], v[204:207], v[228:231]
  v_mfma_f32_16x16x32_bf16 v[236:239], v[44:47], v[204:207], v[236:239]
  s_barrier
  v_lshlrev_b32 v9, 4, v1
  s_xor_b32 s40, s33, 1
  s_mul_i32 s40, s40, 6144
  s_add_u32 s40, s40, 0
  v_add_u32 v10, s40, v9
  ds_write_b128 v10, v[216:219]
  ds_write_b128 v10, v[220:223] offset:1024
  s_xor_b32 s40, s33, 2
  s_mul_i32 s40, s40, 6144
  s_add_u32 s40, s40, 2048
  v_add_u32 v10, s40, v9
  ds_write_b128 v10, v[224:227]
  ds_write_b128 v10, v[228:231] offset:1024
  s_xor_b32 s40, s33, 3
  s_mul_i32 s40, s40, 6144
  s_add_u32 s40, s40, 4096
  v_add_u32 v10, s40, v9
  ds_write_b128 v10, v[232:235]
  ds_write_b128 v10, v[236:239] offset:1024
  s_mul_i32 s40, s33, 6144
  v_add_u32 v10, s40, v9
  s_waitcnt lgkmcnt(0)
  s_barrier
  ds_read_b128 v[32:35], v10 offset:0
  ds_read_b128 v[36:39], v10 offset:1024
  ds_read_b128 v[40:43], v10 offset:2048
  ds_read_b128 v[44:47], v10 offset:3072
  ds_read_b128 v[48:51], v10 offset:4096
  ds_read_b128 v[52:55], v10 offset:5120
  v_lshlrev_b32 v12, 16, v12
  v_lshlrev_b32 v13, 16, v13
  v_lshlrev_b32 v14, 16, v14
  v_lshlrev_b32 v15, 16, v15
  v_lshlrev_b32 v16, 16, v16
  v_lshlrev_b32 v17, 16, v17
  v_lshlrev_b32 v18, 16, v18
  v_lshlrev_b32 v19, 16, v19
  s_waitcnt lgkmcnt(4)
  v_pk_add_f32 v[208:209], v[208:209], v[32:33]
  v_pk_add_f32 v[210:211], v[210:211], v[34:35]
  v_pk_add_f32 v[212:213], v[212:213], v[36:37]
  v_pk_add_f32 v[214:215], v[214:215], v[38:39]
  s_waitcnt lgkmcnt(2)
  v_pk_add_f32 v[208:209], v[208:209], v[40:41]
  v_pk_add_f32 v[210:211], v[210:211], v[42:43]
  v_pk_add_f32 v[212:213], v[212:213], v[44:45]
  v_pk_add_f32 v[214:215], v[214:215], v[46:47]
  s_waitcnt lgkmcnt(0)
  v_pk_add_f32 v[208:209], v[208:209], v[48:49]
  v_pk_add_f32 v[210:211], v[210:211], v[50:51]
  v_pk_add_f32 v[212:213], v[212:213], v[52:53]
  v_pk_add_f32 v[214:215], v[214:215], v[54:55]
  v_cvt_pk_bf16_f32 v56, v208, v209
  v_cvt_pk_bf16_f32 v57, v210, v211
  v_cvt_pk_bf16_f32 v58, v212, v213
  v_cvt_pk_bf16_f32 v59, v214, v215
  v_lshlrev_b32 v208, 16, v56
  v_and_b32 v209, 0xffff0000, v56
  v_lshlrev_b32 v210, 16, v57
  v_and_b32 v211, 0xffff0000, v57
  v_lshlrev_b32 v212, 16, v58
  v_and_b32 v213, 0xffff0000, v58
  v_lshlrev_b32 v214, 16, v59
  v_and_b32 v215, 0xffff0000, v59
  v_pk_add_f32 v[208:209], v[208:209], v[12:13]
  v_pk_add_f32 v[210:211], v[210:211], v[14:15]
  v_pk_add_f32 v[212:213], v[212:213], v[16:17]
  v_pk_add_f32 v[214:215], v[214:215], v[18:19]
  v_cvt_pk_bf16_f32 v56, v208, v209
  v_cvt_pk_bf16_f32 v57, v210, v211
  v_cvt_pk_bf16_f32 v58, v212, v213
  v_cvt_pk_bf16_f32 v59, v214, v215
  s_nop 0
  v_permlane16_swap_b32 v56, v58
  s_nop 0
  v_permlane16_swap_b32 v57, v59
  buffer_store_dwordx4 v[56:59], v7, s[4:7], 0 offen
  s_branch L_kall_end
L_kall_spare:
  s_load_dwordx4 s[52:55], s[0:1], 96
  v_lshrrev_b32 v2, 3, v1
  s_lshl_b32 s34, s2, 6
  s_lshl_b32 s35, s33, 3
  s_add_u32 s34, s34, s35
  v_add_u32 v2, s34, v2
  s_movk_i32 s35, 896
  v_mul_lo_u32 v3, v2, s35
  v_and_b32 v4, 7, v1
  v_lshl_add_u32 v3, v4, 4, v3
  s_waitcnt lgkmcnt(0)
  global_load_dwordx4 v[32:35], v3, s[4:5] offset:0
  global_load_dwordx4 v[36:39], v3, s[4:5] offset:128
  global_load_dwordx4 v[40:43], v3, s[4:5] offset:256
  global_load_dwordx4 v[44:47], v3, s[4:5] offset:384
  global_load_dwordx4 v[48:51], v3, s[4:5] offset:512
  global_load_dwordx4 v[52:55], v3, s[4:5] offset:640
  global_load_dwordx4 v[56:59], v3, s[4:5] offset:768
  v_mov_b32 v24, 59392
  v_mov_b32 v25, 64
  global_load_dword v26, v24, s[26:27]
  global_load_dword v27, v25, s[24:25]
  s_mov_b32 s44, 0x3f803f80
  v_mov_b32 v10, 0
  v_mov_b32 v11, 0
  v_mov_b32 v14, 0
  v_mov_b32 v15, 0
  s_lshl_b32 s40, s2, 9
  s_add_u32 s40, s40, 32768
  v_lshl_add_u32 v20, v1, 3, s40
  v_mov_b32 v18, -1
  v_mov_b32 v19, -1
  v_mov_b32 v28, 0
  v_mov_b32 v29, 0
  v_mov_b32 v30, 0
  v_mov_b32 v31, 0
  s_mov_b64 s[46:47], exec
  s_cmp_lg_u32 s33, 3
  s_cbranch_scc1 L_kall_noci
  s_lshl_b32 s40, s2, 7
  s_add_u32 s40, s40, 49152
  v_lshl_add_u32 v21, v1, 4, s40
  s_mov_b64 exec, 0xff
  global_store_dwordx4 v21, v[28:31], s[26:27] sc1
  s_mov_b64 exec, s[46:47]
L_kall_noci:
  s_cmp_lg_u32 s33, 2
  s_cbranch_scc1 L_kall_nocsi
  s_lshl_b32 s40, s2, 9
  s_add_u32 s40, s40, 16384
  v_lshl_add_u32 v23, v1, 3, s40
  global_store_dwordx2 v23, v[18:19], s[26:27] sc1
L_kall_nocsi:
  s_cmp_lg_u32 s33, 1
  s_cbranch_scc1 L_kall_noinit
  global_store_dwordx2 v20, v[18:19], s[26:27] sc1
L_kall_noinit:
  s_waitcnt vmcnt(8)
  v_dot2_f32_bf16 v10, v32, s44, v10
  v_dot2_f32_bf16 v11, v32, v32, v11
  v_dot2_f32_bf16 v14, v33, s44, v14
  v_dot2_f32_bf16 v15, v33, v33, v15
  v_dot2_f32_bf16 v10, v34, s44, v10
  v_dot2_f32_bf16 v11, v34, v34, v11
  v_dot2_f32_bf16 v14, v35, s44, v14
  v_dot2_f32_bf16 v15, v35, v35, v15
  s_waitcnt vmcnt(7)
  v_dot2_f32_bf16 v10, v36, s44, v10
  v_dot2_f32_bf16 v11, v36, v36, v11
  v_dot2_f32_bf16 v14, v37, s44, v14
  v_dot2_f32_bf16 v15, v37, v37, v15
  v_dot2_f32_bf16 v10, v38, s44, v10
  v_dot2_f32_bf16 v11, v38, v38, v11
  v_dot2_f32_bf16 v14, v39, s44, v14
  v_dot2_f32_bf16 v15, v39, v39, v15
  s_waitcnt vmcnt(6)
  v_dot2_f32_bf16 v10, v40, s44, v10
  v_dot2_f32_bf16 v11, v40, v40, v11
  v_dot2_f32_bf16 v14, v41, s44, v14
  v_dot2_f32_bf16 v15, v41, v41, v15
  v_dot2_f32_bf16 v10, v42, s44, v10
  v_dot2_f32_bf16 v11, v42, v42, v11
  v_dot2_f32_bf16 v14, v43, s44, v14
  v_dot2_f32_bf16 v15, v43, v43, v15
  s_waitcnt vmcnt(5)
  v_dot2_f32_bf16 v10, v44, s44, v10
  v_dot2_f32_bf16 v11, v44, v44, v11
  v_dot2_f32_bf16 v14, v45, s44, v14
  v_dot2_f32_bf16 v15, v45, v45, v15
  v_dot2_f32_bf16 v10, v46, s44, v10
  v_dot2_f32_bf16 v11, v46, v46, v11
  v_dot2_f32_bf16 v14, v47, s44, v14
  v_dot2_f32_bf16 v15, v47, v47, v15
  s_waitcnt vmcnt(4)
  v_dot2_f32_bf16 v10, v48, s44, v10
  v_dot2_f32_bf16 v11, v48, v48, v11
  v_dot2_f32_bf16 v14, v49, s44, v14
  v_dot2_f32_bf16 v15, v49, v49, v15
  v_dot2_f32_bf16 v10, v50, s44, v10
  v_dot2_f32_bf16 v11, v50, v50, v11
  v_dot2_f32_bf16 v14, v51, s44, v14
  v_dot2_f32_bf16 v15, v51, v51, v15
  s_waitcnt vmcnt(3)
  v_dot2_f32_bf16 v10, v52, s44, v10
  v_dot2_f32_bf16 v11, v52, v52, v11
  v_dot2_f32_bf16 v14, v53, s44, v14
  v_dot2_f32_bf16 v15, v53, v53, v15
  v_dot2_f32_bf16 v10, v54, s44, v10
  v_dot2_f32_bf16 v11, v54, v54, v11
  v_dot2_f32_bf16 v14, v55, s44, v14
  v_dot2_f32_bf16 v15, v55, v55, v15
  s_waitcnt vmcnt(2)
  v_dot2_f32_bf16 v10, v56, s44, v10
  v_dot2_f32_bf16 v11, v56, v56, v11
  v_dot2_f32_bf16 v14, v57, s44, v14
  v_dot2_f32_bf16 v15, v57, v57, v15
  v_dot2_f32_bf16 v10, v58, s44, v10
  v_dot2_f32_bf16 v11, v58, v58, v11
  v_dot2_f32_bf16 v14, v59, s44, v14
  v_dot2_f32_bf16 v15, v59, v59, v15
  s_nop 1
  v_add_f32 v10, v10, v14
  s_nop 1
  v_add_f32 v11, v11, v15
  s_nop 0
  v_add_f32_dpp v10, v10, v10 quad_perm:[1,0,3,2] row_mask:0xf bank_mask:0xf
  s_nop 0
  v_add_f32_dpp v11, v11, v11 quad_perm:[1,0,3,2] row_mask:0xf bank_mask:0xf
  s_nop 0
  v_add_f32_dpp v10, v10, v10 quad_perm:[2,3,0,1] row_mask:0xf bank_mask:0xf
  s_nop 0
  v_add_f32_dpp v11, v11, v11 quad_perm:[2,3,0,1] row_mask:0xf bank_mask:0xf
  s_nop 0
  v_add_f32_dpp v10, v10, v10 row_half_mirror row_mask:0xf bank_mask:0xf
  s_nop 0
  v_add_f32_dpp v11, v11, v11 row_half_mirror row_mask:0xf bank_mask:0xf
  s_mov_b32 s40, 0x3b124925
  s_mov_b32 s41, 0x3727c5ac
  v_mul_f32 v10, s40, v10
  v_mul_f32 v11, s40, v11
  v_fma_f32 v11, -v10, v10, v11
  v_max_f32 v11, 0, v11
  v_cvt_pk_bf16_f32 v16, v11, v11
  v_lshlrev_b32 v16, 16, v16
  v_add_f32 v16, s41, v16
  v_cvt_pk_bf16_f32 v16, v16, v16
  v_lshlrev_b32 v16, 16, v16
  v_sqrt_f32 v16, v16
  s_nop 0
  v_cvt_pk_bf16_f32 v16, v10, v16
  v_and_b32 v17, 0xffff0000, v16
  v_lshlrev_b32 v16, 16, v16
  v_rcp_f32 v17, v17
  v_lshrrev_b32 v2, 3, v1
  s_lshl_b32 s40, s33, 3
  v_add_u32 v2, s40, v2
  v_lshlrev_b32 v2, 3, v2
  s_mov_b32 s42, 0x01010101
  s_mov_b32 s43, 0x01010101
  s_mov_b64 exec, s[42:43]
  ds_write_b64 v2, v[16:17]
  s_mov_b64 exec, s[46:47]
  s_waitcnt lgkmcnt(0)
  s_barrier
  s_cmp_lg_u32 s33, 0
  s_cbranch_scc1 L_kall_nost
  v_lshlrev_b32 v2, 3, v1
  ds_read_b64 v[16:17], v2
  s_lshl_b32 s40, s2, 9
  s_add_u32 s40, s40, 0
  v_add_u32 v2, s40, v2
  s_waitcnt lgkmcnt(0)
  global_store_dwordx2 v2, v[16:17], s[26:27] sc1
L_kall_nost:
  s_waitcnt vmcnt(0)
  s_barrier
  s_cmp_lg_u32 s33, 0
  s_cbranch_scc1 L_kall_nosig
  v_mov_b32 v4, 0
  v_mov_b32 v5, 1
  s_mov_b64 exec, 1
  global_atomic_add v4, v5, s[24:25] sc1
  s_mov_b64 exec, s[46:47]
L_kall_nosig:
  s_movk_i32 s35, 4682
  v_mul_u32_u24 v6, s35, v0
  v_lshrrev_b32 v6, 16, v6
  v_mul_u32_u24 v7, 14, v6
  v_sub_u32 v7, v0, v7
  s_and_b32 s36, s2, 15
  s_mul_i32 s36, s36, 224
  s_movk_i32 s35, 3136
  v_mul_u32_u24 v8, s35, v6
  v_lshlrev_b32 v8, 4, v8
  v_lshl_add_u32 v8, v7, 4, v8
  v_add_u32 v8, s36, v8
  s_cmp_lt_u32 s2, 16
  s_cselect_b32 s36, s28, s30
  s_cselect_b32 s37, s29, s31
  s_mov_b32 s38, 1605632
  s_mov_b32 s39, 0x20000
  s_mov_b32 s40, 0
  buffer_load_dwordx4 v[96:99], v8, s[36:39], 0 offen
  v_add_u32 v8, 3584, v8
  buffer_load_dwordx4 v[100:103], v8, s[36:39], 0 offen
  v_add_u32 v8, 3584, v8
  buffer_load_dwordx4 v[104:107], v8, s[36:39], 0 offen
  v_add_u32 v8, 3584, v8
  buffer_load_dwordx4 v[108:111], v8, s[36:39], 0 offen
  v_add_u32 v8, 3584, v8
  buffer_load_dwordx4 v[112:115], v8, s[36:39], 0 offen
  v_add_u32 v8, 3584, v8
  buffer_load_dwordx4 v[116:119], v8, s[36:39], 0 offen
  v_add_u32 v8, 3584, v8
  buffer_load_dwordx4 v[120:123], v8, s[36:39], 0 offen
  v_add_u32 v8, 3584, v8
  buffer_load_dwordx4 v[124:127], v8, s[36:39], 0 offen
  v_add_u32 v8, 3584, v8
  buffer_load_dwordx4 v[128:131], v8, s[36:39], 0 offen
  v_add_u32 v8, 3584, v8
  buffer_load_dwordx4 v[132:135], v8, s[36:39], 0 offen
  v_add_u32 v8, 3584, v8
  buffer_load_dwordx4 v[136:139], v8, s[36:39], 0 offen
  v_add_u32 v8, 3584, v8
  buffer_load_dwordx4 v[140:143], v8, s[36:39], 0 offen
  v_add_u32 v8, 3584, v8
  buffer_load_dwordx4 v[144:147], v8, s[36:39], 0 offen
  v_add_u32 v8, 3584, v8
  buffer_load_dwordx4 v[148:151], v8, s[36:39], 0 offen
  s_mov_b32 s56, s52
  s_mov_b32 s57, s53
  s_mov_b32 s58, 1605632
  s_mov_b32 s59, 0x20000
  s_mul_i32 s40, s2, 50176
  v_lshl_add_u32 v11, v0, 4, s40
  buffer_load_dwordx4 v[152:155], v11, s[56:59], 0 offen
  v_add_u32 v11, 8192, v11
  buffer_load_dwordx4 v[156:159], v11, s[56:59], 0 offen
  v_add_u32 v11, 8192, v11
  buffer_load_dwordx4 v[160:163], v11, s[56:59], 0 offen
  v_add_u32 v11, 8192, v11
  buffer_load_dwordx4 v[164:167], v11, s[56:59], 0 offen
  v_add_u32 v11, 8192, v11
  buffer_load_dwordx4 v[168:171], v11, s[56:59], 0 offen
  v_add_u32 v11, 8192, v11
  buffer_load_dwordx4 v[172:175], v11, s[56:59], 0 offen
  v_add_u32 v11, 8192, v11
  buffer_load_dwordx4 v[176:179], v11, s[56:59], 0 offen
  v_mov_b32 v32, 0
  v_mov_b32 v33, 0
  v_mov_b32 v34, 0
  v_mov_b32 v35, 0
  v_mov_b32 v36, 0
  v_mov_b32 v37, 0
  v_mov_b32 v38, 0
  v_mov_b32 v39, 0
  s_mov_b32 s44, 0xffff0000
  s_waitcnt vmcnt(20)
  v_lshlrev_b32 v40, 16, v96
  v_and_b32 v41, s44, v96
  v_pk_add_f32 v[32:33], v[32:33], v[40:41]
  v_lshlrev_b32 v42, 16, v97
  v_and_b32 v43, s44, v97
  v_pk_add_f32 v[34:35], v[34:35], v[42:43]
  v_lshlrev_b32 v40, 16, v98
  v_and_b32 v41, s44, v98
  v_pk_add_f32 v[36:37], v[36:37], v[40:41]
  v_lshlrev_b32 v42, 16, v99
  v_and_b32 v43, s44, v99
  v_pk_add_f32 v[38:39], v[38:39], v[42:43]
  s_waitcnt vmcnt(19)
  v_lshlrev_b32 v40, 16, v100
  v_and_b32 v41, s44, v100
  v_pk_add_f32 v[32:33], v[32:33], v[40:41]
  v_lshlrev_b32 v42, 16, v101
  v_and_b32 v43, s44, v101
  v_pk_add_f32 v[34:35], v[34:35], v[42:43]
  v_lshlrev_b32 v40, 16, v102
  v_and_b32 v41, s44, v102
  v_pk_add_f32 v[36:37], v[36:37], v[40:41]
  v_lshlrev_b32 v42, 16, v103
  v_and_b32 v43, s44, v103
  v_pk_add_f32 v[38:39], v[38:39], v[42:43]
  s_waitcnt vmcnt(18)
  v_lshlrev_b32 v40, 16, v104
  v_and_b32 v41, s44, v104
  v_pk_add_f32 v[32:33], v[32:33], v[40:41]
  v_lshlrev_b32 v42, 16, v105
  v_and_b32 v43, s44, v105
  v_pk_add_f32 v[34:35], v[34:35], v[42:43]
  v_lshlrev_b32 v40, 16, v106
  v_and_b32 v41, s44, v106
  v_pk_add_f32 v[36:37], v[36:37], v[40:41]
  v_lshlrev_b32 v42, 16, v107
  v_and_b32 v43, s44, v107
  v_pk_add_f32 v[38:39], v[38:39], v[42:43]
  s_waitcnt vmcnt(17)
  v_lshlrev_b32 v40, 16, v108
  v_and_b32 v41, s44, v108
  v_pk_add_f32 v[32:33], v[32:33], v[40:41]
  v_lshlrev_b32 v42, 16, v109
  v_and_b32 v43, s44, v109
  v_pk_add_f32 v[34:35], v[34:35], v[42:43]
  v_lshlrev_b32 v40, 16, v110
  v_and_b32 v41, s44, v110
  v_pk_add_f32 v[36:37], v[36:37], v[40:41]
  v_lshlrev_b32 v42, 16, v111
  v_and_b32 v43, s44, v111
  v_pk_add_f32 v[38:39], v[38:39], v[42:43]
  s_waitcnt vmcnt(16)
  v_lshlrev_b32 v40, 16, v112
  v_and_b32 v41, s44, v112
  v_pk_add_f32 v[32:33], v[32:33], v[40:41]
  v_lshlrev_b32 v42, 16, v113
  v_and_b32 v43, s44, v113
  v_pk_add_f32 v[34:35], v[34:35], v[42:43]
  v_lshlrev_b32 v40, 16, v114
  v_and_b32 v41, s44, v114
  v_pk_add_f32 v[36:37], v[36:37], v[40:41]
  v_lshlrev_b32 v42, 16, v115
  v_and_b32 v43, s44, v115
  v_pk_add_f32 v[38:39], v[38:39], v[42:43]
  s_waitcnt vmcnt(15)
  v_lshlrev_b32 v40, 16, v116
  v_and_b32 v41, s44, v116
  v_pk_add_f32 v[32:33], v[32:33], v[40:41]
  v_lshlrev_b32 v42, 16, v117
  v_and_b32 v43, s44, v117
  v_pk_add_f32 v[34:35], v[34:35], v[42:43]
  v_lshlrev_b32 v40, 16, v118
  v_and_b32 v41, s44, v118
  v_pk_add_f32 v[36:37], v[36:37], v[40:41]
  v_lshlrev_b32 v42, 16, v119
  v_and_b32 v43, s44, v119
  v_pk_add_f32 v[38:39], v[38:39], v[42:43]
  s_waitcnt vmcnt(14)
  v_lshlrev_b32 v40, 16, v120
  v_and_b32 v41, s44, v120
  v_pk_add_f32 v[32:33], v[32:33], v[40:41]
  v_lshlrev_b32 v42, 16, v121
  v_and_b32 v43, s44, v121
  v_pk_add_f32 v[34:35], v[34:35], v[42:43]
  v_lshlrev_b32 v40, 16, v122
  v_and_b32 v41, s44, v122
  v_pk_add_f32 v[36:37], v[36:37], v[40:41]
  v_lshlrev_b32 v42, 16, v123
  v_and_b32 v43, s44, v123
  v_pk_add_f32 v[38:39], v[38:39], v[42:43]
  s_waitcnt vmcnt(13)
  v_lshlrev_b32 v40, 16, v124
  v_and_b32 v41, s44, v124
  v_pk_add_f32 v[32:33], v[32:33], v[40:41]
  v_lshlrev_b32 v42, 16, v125
  v_and_b32 v43, s44, v125
  v_pk_add_f32 v[34:35], v[34:35], v[42:43]
  v_lshlrev_b32 v40, 16, v126
  v_and_b32 v41, s44, v126
  v_pk_add_f32 v[36:37], v[36:37], v[40:41]
  v_lshlrev_b32 v42, 16, v127
  v_and_b32 v43, s44, v127
  v_pk_add_f32 v[38:39], v[38:39], v[42:43]
  s_waitcnt vmcnt(12)
  v_lshlrev_b32 v40, 16, v128
  v_and_b32 v41, s44, v128
  v_pk_add_f32 v[32:33], v[32:33], v[40:41]
  v_lshlrev_b32 v42, 16, v129
  v_and_b32 v43, s44, v129
  v_pk_add_f32 v[34:35], v[34:35], v[42:43]
  v_lshlrev_b32 v40, 16, v130
  v_and_b32 v41, s44, v130
  v_pk_add_f32 v[36:37], v[36:37], v[40:41]
  v_lshlrev_b32 v42, 16, v131
  v_and_b32 v43, s44, v131
  v_pk_add_f32 v[38:39], v[38:39], v[42:43]
  s_waitcnt vmcnt(11)
  v_lshlrev_b32 v40, 16, v132
  v_and_b32 v41, s44, v132
  v_pk_add_f32 v[32:33], v[32:33], v[40:41]
  v_lshlrev_b32 v42, 16, v133
  v_and_b32 v43, s44, v133
  v_pk_add_f32 v[34:35], v[34:35], v[42:43]
  v_lshlrev_b32 v40, 16, v134
  v_and_b32 v41, s44, v134
  v_pk_add_f32 v[36:37], v[36:37], v[40:41]
  v_lshlrev_b32 v42, 16, v135
  v_and_b32 v43, s44, v135
  v_pk_add_f32 v[38:39], v[38:39], v[42:43]
  s_waitcnt vmcnt(10)
  v_lshlrev_b32 v40, 16, v136
  v_and_b32 v41, s44, v136
  v_pk_add_f32 v[32:33], v[32:33], v[40:41]
  v_lshlrev_b32 v42, 16, v137
  v_and_b32 v43, s44, v137
  v_pk_add_f32 v[34:35], v[34:35], v[42:43]
  v_lshlrev_b32 v40, 16, v138
  v_and_b32 v41, s44, v138
  v_pk_add_f32 v[36:37], v[36:37], v[40:41]
  v_lshlrev_b32 v42, 16, v139
  v_and_b32 v43, s44, v139
  v_pk_add_f32 v[38:39], v[38:39], v[42:43]
  s_waitcnt vmcnt(9)
  v_lshlrev_b32 v40, 16, v140
  v_and_b32 v41, s44, v140
  v_pk_add_f32 v[32:33], v[32:33], v[40:41]
  v_lshlrev_b32 v42, 16, v141
  v_and_b32 v43, s44, v141
  v_pk_add_f32 v[34:35], v[34:35], v[42:43]
  v_lshlrev_b32 v40, 16, v142
  v_and_b32 v41, s44, v142
  v_pk_add_f32 v[36:37], v[36:37], v[40:41]
  v_lshlrev_b32 v42, 16, v143
  v_and_b32 v43, s44, v143
  v_pk_add_f32 v[38:39], v[38:39], v[42:43]
  s_waitcnt vmcnt(8)
  v_lshlrev_b32 v40, 16, v144
  v_and_b32 v41, s44, v144
  v_pk_add_f32 v[32:33], v[32:33], v[40:41]
  v_lshlrev_b32 v42, 16, v145
  v_and_b32 v43, s44, v145
  v_pk_add_f32 v[34:35], v[34:35], v[42:43]
  v_lshlrev_b32 v40, 16, v146
  v_and_b32 v41, s44, v146
  v_pk_add_f32 v[36:37], v[36:37], v[40:41]
  v_lshlrev_b32 v42, 16, v147
  v_and_b32 v43, s44, v147
  v_pk_add_f32 v[38:39], v[38:39], v[42:43]
  s_waitcnt vmcnt(7)
  v_lshlrev_b32 v40, 16, v148
  v_and_b32 v41, s44, v148
  v_pk_add_f32 v[32:33], v[32:33], v[40:41]
  v_lshlrev_b32 v42, 16, v149
  v_and_b32 v43, s44, v149
  v_pk_add_f32 v[34:35], v[34:35], v[42:43]
  v_lshlrev_b32 v40, 16, v150
  v_and_b32 v41, s44, v150
  v_pk_add_f32 v[36:37], v[36:37], v[40:41]
  v_lshlrev_b32 v42, 16, v151
  v_and_b32 v43, s44, v151
  v_pk_add_f32 v[38:39], v[38:39], v[42:43]
  s_movk_i32 s35, 448
  v_mul_u32_u24 v9, s35, v6
  v_lshl_add_u32 v9, v7, 5, v9
  v_mov_b32 v10, 448
  v_cmp_gt_u32 vcc, v10, v0
  s_nop 0
  s_and_saveexec_b64 s[42:43], vcc
  s_cbranch_execz L_kall_csnw
  ds_write_b128 v9, v[32:35]
  ds_write_b128 v9, v[36:39] offset:16
L_kall_csnw:
  s_mov_b64 exec, s[42:43]
  s_waitcnt lgkmcnt(0)
  s_barrier
  v_mov_b32 v10, 112
  v_cmp_gt_u32 vcc, v10, v0
  s_nop 0
  s_and_saveexec_b64 s[42:43], vcc
  s_cbranch_execz L_kall_csdone
  v_lshlrev_b32 v9, 2, v0
  ds_read_b32 v32, v9 offset:0
  ds_read_b32 v33, v9 offset:448
  ds_read_b32 v34, v9 offset:896
  ds_read_b32 v35, v9 offset:1344
  ds_read_b32 v36, v9 offset:1792
  ds_read_b32 v37, v9 offset:2240
  ds_read_b32 v38, v9 offset:2688
  ds_read_b32 v39, v9 offset:3136
  ds_read_b32 v40, v9 offset:3584
  ds_read_b32 v41, v9 offset:4032
  ds_read_b32 v42, v9 offset:4480
  ds_read_b32 v43, v9 offset:4928
  ds_read_b32 v44, v9 offset:5376
  ds_read_b32 v45, v9 offset:5824
  ds_read_b32 v46, v9 offset:6272
  ds_read_b32 v47, v9 offset:6720
  ds_read_b32 v48, v9 offset:7168
  ds_read_b32 v49, v9 offset:7616
  ds_read_b32 v50, v9 offset:8064
  ds_read_b32 v51, v9 offset:8512
  ds_read_b32 v52, v9 offset:8960
  ds_read_b32 v53, v9 offset:9408
  ds_read_b32 v54, v9 offset:9856
  ds_read_b32 v55, v9 offset:10304
  ds_read_b32 v56, v9 offset:10752
  ds_read_b32 v57, v9 offset:11200
  ds_read_b32 v58, v9 offset:11648
  ds_read_b32 v59, v9 offset:12096
  ds_read_b32 v60, v9 offset:12544
  ds_read_b32 v61, v9 offset:12992
  ds_read_b32 v62, v9 offset:13440
  ds_read_b32 v63, v9 offset:13888
  s_waitcnt lgkmcnt(0)
  v_add_f32 v32, v32, v33
  v_add_f32 v34, v34, v35
  v_add_f32 v36, v36, v37
  v_add_f32 v38, v38, v39
  v_add_f32 v40, v40, v41
  v_add_f32 v42, v42, v43
  v_add_f32 v44, v44, v45
  v_add_f32 v46, v46, v47
  v_add_f32 v48, v48, v49
  v_add_f32 v50, v50, v51
  v_add_f32 v52, v52, v53
  v_add_f32 v54, v54, v55
  v_add_f32 v56, v56, v57
  v_add_f32 v58, v58, v59
  v_add_f32 v60, v60, v61
  v_add_f32 v62, v62, v63
  v_add_f32 v32, v32, v34
  v_add_f32 v32, v32, v36
  v_add_f32 v32, v32, v38
  v_add_f32 v32, v32, v40
  v_add_f32 v32, v32, v42
  v_add_f32 v32, v32, v44
  v_add_f32 v32, v32, v46
  v_add_f32 v32, v32, v48
  v_add_f32 v32, v32, v50
  v_add_f32 v32, v32, v52
  v_add_f32 v32, v32, v54
  v_add_f32 v32, v32, v56
  v_add_f32 v32, v32, v58
  v_add_f32 v32, v32, v60
  v_add_f32 v32, v32, v62
  s_lshl_b32 s40, s2, 9
  s_add_u32 s40, s40, 16384
  v_add_u32 v9, s40, v9
  global_store_dword v9, v32, s[26:27] sc1
L_kall_csdone:
  s_mov_b64 exec, s[42:43]
  s_waitcnt vmcnt(0)
  s_load_dwordx2 s[12:13], s[0:1], 120
  s_load_dwordx4 s[4:7], s[0:1], 96
  s_barrier
  s_cmp_lg_u32 s33, 0
  s_cbranch_scc1 L_kall_sp2w
  v_mov_b32 v12, 0
  s_mov_b32 s58, 0
L_kall_sp1p:
  global_load_dword v13, v12, s[24:25] offset:0 sc1
  s_waitcnt vmcnt(0)
  v_readfirstlane_b32 s40, v13
  s_add_u32 s58, s58, 1
  s_cmp_ge_u32 s40, 32
  s_cbranch_scc1 L_kall_sp1d
  s_cmp_ge_u32 s58, 0x40000
  s_cbranch_scc1 L_kall_sp1d
  s_sleep 8
  s_branch L_kall_sp1p
L_kall_sp1d:
  s_waitcnt lgkmcnt(0)
  s_and_b32 s40, s2, 7
  s_lshl_b32 s40, s40, 7
  s_add_u32 s41, s40, 52224
  v_mov_b32 v12, s41
  s_mov_b32 s58, 0
L_kall_sp2p:
  global_load_dword v13, v12, s[12:13] sc1
  s_waitcnt vmcnt(0)
  v_readfirstlane_b32 s41, v13
  s_add_u32 s58, s58, 1
  s_cmp_ge_u32 s41, 8
  s_cbranch_scc1 L_kall_sp2w
  s_cmp_ge_u32 s58, 0x40000
  s_cbranch_scc1 L_kall_sp2w
  s_sleep 8
  s_branch L_kall_sp2p
L_kall_sp2w:
  s_waitcnt lgkmcnt(0)
  s_barrier
  s_waitcnt lgkmcnt(0)
  s_add_u32 s16, s12, 65536
  s_addc_u32 s17, s13, 0
  s_mov_b32 s18, 1835008
  s_mov_b32 s19, 0x20000
  v_and_b32 v2, 7, v0
  v_lshrrev_b32 v3, 3, v0
  v_lshlrev_b32 v4, 12, v3
  v_lshl_add_u32 v4, v2, 4, v4
  s_lshl_b32 s40, s2, 7
  v_add_u32 v4, s40, v4
  s_mov_b32 s42, 0
  buffer_load_dwordx4 v[32:35], v4, s[16:19], s42 offen sc1
  s_add_u32 s42, s42, 262144
  buffer_load_dwordx4 v[36:39], v4, s[16:19], s42 offen sc1
  s_add_u32 s42, s42, 262144
  buffer_load_dwordx4 v[40:43], v4, s[16:19], s42 offen sc1
  s_add_u32 s42, s42, 262144
  buffer_load_dwordx4 v[44:47], v4, s[16:19], s42 offen sc1
  s_add_u32 s42, s42, 262144
  buffer_load_dwordx4 v[48:51], v4, s[16:19], s42 offen sc1
  s_add_u32 s42, s42, 262144
  buffer_load_dwordx4 v[52:55], v4, s[16:19], s42 offen sc1
  s_add_u32 s42, s42, 262144
  buffer_load_dwordx4 v[56:59], v4, s[16:19], s42 offen sc1
  s_add_u32 s42, s42, 262144
  v_mov_b32 v64, 0
  v_mov_b32 v65, 0
  v_mov_b32 v66, 0
  v_mov_b32 v67, 0
  v_mov_b32 v68, 0
  v_mov_b32 v69, 0
  v_mov_b32 v70, 0
  v_mov_b32 v71, 0
  v_mov_b32 v72, 0
  v_mov_b32 v73, 0
  v_mov_b32 v74, 0
  v_mov_b32 v75, 0
  v_mov_b32 v76, 0
  v_mov_b32 v77, 0
  v_mov_b32 v78, 0
  v_mov_b32 v79, 0
  s_mov_b32 s52, 0xffff0000
  s_waitcnt vmcnt(6)
  v_lshlrev_b32 v16, 16, v32
  v_and_b32 v17, s52, v32
  v_pk_add_f32 v[64:65], v[64:65], v[16:17]
  v_pk_fma_f32 v[72:73], v[16:17], v[16:17], v[72:73]
  v_lshlrev_b32 v16, 16, v33
  v_and_b32 v17, s52, v33
  v_pk_add_f32 v[66:67], v[66:67], v[16:17]
  v_pk_fma_f32 v[74:75], v[16:17], v[16:17], v[74:75]
  v_lshlrev_b32 v16, 16, v34
  v_and_b32 v17, s52, v34
  v_pk_add_f32 v[68:69], v[68:69], v[16:17]
  v_pk_fma_f32 v[76:77], v[16:17], v[16:17], v[76:77]
  v_lshlrev_b32 v16, 16, v35
  v_and_b32 v17, s52, v35
  v_pk_add_f32 v[70:71], v[70:71], v[16:17]
  v_pk_fma_f32 v[78:79], v[16:17], v[16:17], v[78:79]
  s_waitcnt vmcnt(5)
  v_lshlrev_b32 v16, 16, v36
  v_and_b32 v17, s52, v36
  v_pk_add_f32 v[64:65], v[64:65], v[16:17]
  v_pk_fma_f32 v[72:73], v[16:17], v[16:17], v[72:73]
  v_lshlrev_b32 v16, 16, v37
  v_and_b32 v17, s52, v37
  v_pk_add_f32 v[66:67], v[66:67], v[16:17]
  v_pk_fma_f32 v[74:75], v[16:17], v[16:17], v[74:75]
  v_lshlrev_b32 v16, 16, v38
  v_and_b32 v17, s52, v38
  v_pk_add_f32 v[68:69], v[68:69], v[16:17]
  v_pk_fma_f32 v[76:77], v[16:17], v[16:17], v[76:77]
  v_lshlrev_b32 v16, 16, v39
  v_and_b32 v17, s52, v39
  v_pk_add_f32 v[70:71], v[70:71], v[16:17]
  v_pk_fma_f32 v[78:79], v[16:17], v[16:17], v[78:79]
  s_waitcnt vmcnt(4)
  v_lshlrev_b32 v16, 16, v40
  v_and_b32 v17, s52, v40
  v_pk_add_f32 v[64:65], v[64:65], v[16:17]
  v_pk_fma_f32 v[72:73], v[16:17], v[16:17], v[72:73]
  v_lshlrev_b32 v16, 16, v41
  v_and_b32 v17, s52, v41
  v_pk_add_f32 v[66:67], v[66:67], v[16:17]
  v_pk_fma_f32 v[74:75], v[16:17], v[16:17], v[74:75]
  v_lshlrev_b32 v16, 16, v42
  v_and_b32 v17, s52, v42
  v_pk_add_f32 v[68:69], v[68:69], v[16:17]
  v_pk_fma_f32 v[76:77], v[16:17], v[16:17], v[76:77]
  v_lshlrev_b32 v16, 16, v43
  v_and_b32 v17, s52, v43
  v_pk_add_f32 v[70:71], v[70:71], v[16:17]
  v_pk_fma_f32 v[78:79], v[16:17], v[16:17], v[78:79]
  s_waitcnt vmcnt(3)
  v_lshlrev_b32 v16, 16, v44
  v_and_b32 v17, s52, v44
  v_pk_add_f32 v[64:65], v[64:65], v[16:17]
  v_pk_fma_f32 v[72:73], v[16:17], v[16:17], v[72:73]
  v_lshlrev_b32 v16, 16, v45
  v_and_b32 v17, s52, v45
  v_pk_add_f32 v[66:67], v[66:67], v[16:17]
  v_pk_fma_f32 v[74:75], v[16:17], v[16:17], v[74:75]
  v_lshlrev_b32 v16, 16, v46
  v_and_b32 v17, s52, v46
  v_pk_add_f32 v[68:69], v[68:69], v[16:17]
  v_pk_fma_f32 v[76:77], v[16:17], v[16:17], v[76:77]
  v_lshlrev_b32 v16, 16, v47
  v_and_b32 v17, s52, v47
  v_pk_add_f32 v[70:71], v[70:71], v[16:17]
  v_pk_fma_f32 v[78:79], v[16:17], v[16:17], v[78:79]
  s_waitcnt vmcnt(2)
  v_lshlrev_b32 v16, 16, v48
  v_and_b32 v17, s52, v48
  v_pk_add_f32 v[64:65], v[64:65], v[16:17]
  v_pk_fma_f32 v[72:73], v[16:17], v[16:17], v[72:73]
  v_lshlrev_b32 v16, 16, v49
  v_and_b32 v17, s52, v49
  v_pk_add_f32 v[66:67], v[66:67], v[16:17]
  v_pk_fma_f32 v[74:75], v[16:17], v[16:17], v[74:75]
  v_lshlrev_b32 v16, 16, v50
  v_and_b32 v17, s52, v50
  v_pk_add_f32 v[68:69], v[68:69], v[16:17]
  v_pk_fma_f32 v[76:77], v[16:17], v[16:17], v[76:77]
  v_lshlrev_b32 v16, 16, v51
  v_and_b32 v17, s52, v51
  v_pk_add_f32 v[70:71], v[70:71], v[16:17]
  v_pk_fma_f32 v[78:79], v[16:17], v[16:17], v[78:79]
  s_waitcnt vmcnt(1)
  v_lshlrev_b32 v16, 16, v52
  v_and_b32 v17, s52, v52
  v_pk_add_f32 v[64:65], v[64:65], v[16:17]
  v_pk_fma_f32 v[72:73], v[16:17], v[16:17], v[72:73]
  v_lshlrev_b32 v16, 16, v53
  v_and_b32 v17, s52, v53
  v_pk_add_f32 v[66:67], v[66:67], v[16:17]
  v_pk_fma_f32 v[74:75], v[16:17], v[16:17], v[74:75]
  v_lshlrev_b32 v16, 16, v54
  v_and_b32 v17, s52, v54
  v_pk_add_f32 v[68:69], v[68:69], v[16:17]
  v_pk_fma_f32 v[76:77], v[16:17], v[16:17], v[76:77]
  v_lshlrev_b32 v16, 16, v55
  v_and_b32 v17, s52, v55
  v_pk_add_f32 v[70:71], v[70:71], v[16:17]
  v_pk_fma_f32 v[78:79], v[16:17], v[16:17], v[78:79]
  s_waitcnt vmcnt(0)
  v_lshlrev_b32 v16, 16, v56
  v_and_b32 v17, s52, v56
  v_pk_add_f32 v[64:65], v[64:65], v[16:17]
  v_pk_fma_f32 v[72:73], v[16:17], v[16:17], v[72:73]
  v_lshlrev_b32 v16, 16, v57
  v_and_b32 v17, s52, v57
  v_pk_add_f32 v[66:67], v[66:67], v[16:17]
  v_pk_fma_f32 v[74:75], v[16:17], v[16:17], v[74:75]
  v_lshlrev_b32 v16, 16, v58
  v_and_b32 v17, s52, v58
  v_pk_add_f32 v[68:69], v[68:69], v[16:17]
  v_pk_fma_f32 v[76:77], v[16:17], v[16:17], v[76:77]
  v_lshlrev_b32 v16, 16, v59
  v_and_b32 v17, s52, v59
  v_pk_add_f32 v[70:71], v[70:71], v[16:17]
  v_pk_fma_f32 v[78:79], v[16:17], v[16:17], v[78:79]
  v_add_f32_dpp v64, v64, v64 row_ror:8 row_mask:0xf bank_mask:0xf
  v_add_f32_dpp v65, v65, v65 row_ror:8 row_mask:0xf bank_mask:0xf
  v_add_f32_dpp v66, v66, v66 row_ror:8 row_mask:0xf bank_mask:0xf
  v_add_f32_dpp v67, v67, v67 row_ror:8 row_mask:0xf bank_mask:0xf
  v_add_f32_dpp v68, v68, v68 row_ror:8 row_mask:0xf bank_mask:0xf
  v_add_f32_dpp v69, v69, v69 row_ror:8 row_mask:0xf bank_mask:0xf
  v_add_f32_dpp v70, v70, v70 row_ror:8 row_mask:0xf bank_mask:0xf
  v_add_f32_dpp v71, v71, v71 row_ror:8 row_mask:0xf bank_mask:0xf
  v_add_f32_dpp v72, v72, v72 row_ror:8 row_mask:0xf bank_mask:0xf
  v_add_f32_dpp v73, v73, v73 row_ror:8 row_mask:0xf bank_mask:0xf
  v_add_f32_dpp v74, v74, v74 row_ror:8 row_mask:0xf bank_mask:0xf
  v_add_f32_dpp v75, v75, v75 row_ror:8 row_mask:0xf bank_mask:0xf
  v_add_f32_dpp v76, v76, v76 row_ror:8 row_mask:0xf bank_mask:0xf
  v_add_f32_dpp v77, v77, v77 row_ror:8 row_mask:0xf bank_mask:0xf
  v_add_f32_dpp v78, v78, v78 row_ror:8 row_mask:0xf bank_mask:0xf
  v_add_f32_dpp v79, v79, v79 row_ror:8 row_mask:0xf bank_mask:0xf
  v_mov_b32 v32, v64
  v_mov_b32 v33, v65
  v_mov_b32 v34, v66
  v_mov_b32 v35, v67
  v_mov_b32 v36, v68
  v_mov_b32 v37, v69
  v_mov_b32 v38, v70
  v_mov_b32 v39, v71
  v_mov_b32 v40, v72
  v_mov_b32 v41, v73
  v_mov_b32 v42, v74
  v_mov_b32 v43, v75
  v_mov_b32 v44, v76
  v_mov_b32 v45, v77
  v_mov_b32 v46, v78
  v_mov_b32 v47, v79
  v_permlane16_swap_b32 v64, v32
  v_permlane16_swap_b32 v65, v33
  v_permlane16_swap_b32 v66, v34
  v_permlane16_swap_b32 v67, v35
  v_permlane16_swap_b32 v68, v36
  v_permlane16_swap_b32 v69, v37
  v_permlane16_swap_b32 v70, v38
  v_permlane16_swap_b32 v71, v39
  v_permlane16_swap_b32 v72, v40
  v_permlane16_swap_b32 v73, v41
  v_permlane16_swap_b32 v74, v42
  v_permlane16_swap_b32 v75, v43
  v_permlane16_swap_b32 v76, v44
  v_permlane16_swap_b32 v77, v45
  v_permlane16_swap_b32 v78, v46
  v_permlane16_swap_b32 v79, v47
  v_add_f32 v64, v64, v32
  v_add_f32 v65, v65, v33
  v_add_f32 v66, v66, v34
  v_add_f32 v67, v67, v35
  v_add_f32 v68, v68, v36
  v_add_f32 v69, v69, v37
  v_add_f32 v70, v70, v38
  v_add_f32 v71, v71, v39
  v_add_f32 v72, v72, v40
  v_add_f32 v73, v73, v41
  v_add_f32 v74, v74, v42
  v_add_f32 v75, v75, v43
  v_add_f32 v76, v76, v44
  v_add_f32 v77, v77, v45
  v_add_f32 v78, v78, v46
  v_add_f32 v79, v79, v47
  v_mov_b32 v32, v64
  v_mov_b32 v33, v65
  v_mov_b32 v34, v66
  v_mov_b32 v35, v67
  v_mov_b32 v36, v68
  v_mov_b32 v37, v69
  v_mov_b32 v38, v70
  v_mov_b32 v39, v71
  v_mov_b32 v40, v72
  v_mov_b32 v41, v73
  v_mov_b32 v42, v74
  v_mov_b32 v43, v75
  v_mov_b32 v44, v76
  v_mov_b32 v45, v77
  v_mov_b32 v46, v78
  v_mov_b32 v47, v79
  v_permlane32_swap_b32 v64, v32
  v_permlane32_swap_b32 v65, v33
  v_permlane32_swap_b32 v66, v34
  v_permlane32_swap_b32 v67, v35
  v_permlane32_swap_b32 v68, v36
  v_permlane32_swap_b32 v69, v37
  v_permlane32_swap_b32 v70, v38
  v_permlane32_swap_b32 v71, v39
  v_permlane32_swap_b32 v72, v40
  v_permlane32_swap_b32 v73, v41
  v_permlane32_swap_b32 v74, v42
  v_permlane32_swap_b32 v75, v43
  v_permlane32_swap_b32 v76, v44
  v_permlane32_swap_b32 v77, v45
  v_permlane32_swap_b32 v78, v46
  v_permlane32_swap_b32 v79, v47
  v_add_f32 v64, v64, v32
  v_add_f32 v65, v65, v33
  v_add_f32 v66, v66, v34
  v_add_f32 v67, v67, v35
  v_add_f32 v68, v68, v36
  v_add_f32 v69, v69, v37
  v_add_f32 v70, v70, v38
  v_add_f32 v71, v71, v39
  v_add_f32 v72, v72, v40
  v_add_f32 v73, v73, v41
  v_add_f32 v74, v74, v42
  v_add_f32 v75, v75, v43
  v_add_f32 v76, v76, v44
  v_add_f32 v77, v77, v45
  v_add_f32 v78, v78, v46
  v_add_f32 v79, v79, v47
  v_lshrrev_b32 v5, 6, v0
  v_and_b32 v6, 63, v0
  v_lshlrev_b32 v7, 9, v5
  v_lshl_add_u32 v7, v6, 5, v7
  s_mov_b64 s[56:57], exec
  s_mov_b64 exec, 0xff
  ds_write_b128 v7, v[64:67]
  ds_write_b128 v7, v[68:71] offset:16
  ds_write_b128 v7, v[72:75] offset:256
  ds_write_b128 v7, v[76:79] offset:272
  s_mov_b64 exec, s[56:57]
  s_waitcnt lgkmcnt(0)
  s_barrier
  s_cmp_lg_u32 s33, 0
  s_cbranch_scc1 L_kall_stail
  v_lshlrev_b32 v7, 2, v6
  ds_read2st64_b32 v[32:33], v7 offset0:0 offset1:1
  ds_read2st64_b32 v[34:35], v7 offset0:2 offset1:3
  ds_read2st64_b32 v[36:37], v7 offset0:4 offset1:5
  ds_read2st64_b32 v[38:39], v7 offset0:6 offset1:7
  ds_read2st64_b32 v[40:41], v7 offset0:8 offset1:9
  ds_read2st64_b32 v[42:43], v7 offset0:10 offset1:11
  ds_read2st64_b32 v[44:45], v7 offset0:12 offset1:13
  ds_read2st64_b32 v[46:47], v7 offset0:14 offset1:15
  s_waitcnt lgkmcnt(0)
  v_pk_add_f32 v[32:33], v[32:33], v[34:35]
  v_pk_add_f32 v[32:33], v[32:33], v[36:37]
  v_pk_add_f32 v[32:33], v[32:33], v[38:39]
  v_pk_add_f32 v[32:33], v[32:33], v[40:41]
  v_pk_add_f32 v[32:33], v[32:33], v[42:43]
  v_pk_add_f32 v[32:33], v[32:33], v[44:45]
  v_pk_add_f32 v[32:33], v[32:33], v[46:47]
  s_mov_b32 s40, 0x3b124925
  s_mov_b32 s41, 0x3727c5ac
  v_mul_f32 v32, s40, v32
  v_mul_f32 v33, s40, v33
  v_fma_f32 v33, -v32, v32, v33
  v_max_f32 v33, 0, v33
  v_cvt_pk_bf16_f32 v34, v33, v32
  v_and_b32 v32, 0xffff0000, v34
  v_lshlrev_b32 v34, 16, v34
  v_add_f32 v34, s41, v34
  v_cvt_pk_bf16_f32 v34, v34, v34
  v_lshlrev_b32 v34, 16, v34
  v_sqrt_f32 v34, v34
  s_nop 0
  v_cvt_pk_bf16_f32 v34, v34, v34
  v_lshlrev_b32 v34, 16, v34
  v_rcp_f32 v33, v34
  s_lshl_b32 s40, s2, 9
  s_add_u32 s40, s40, 32768
  v_lshl_add_u32 v7, v6, 3, s40
  global_store_dwordx2 v7, v[32:33], s[12:13] sc1
L_kall_stail:
  s_lshr_b32 s40, s2, 3
  s_mul_i32 s40, s40, 401408
  v_lshlrev_b32 v8, 4, v0
  v_add_u32 v8, s40, v8
  s_mov_b32 s16, s4
  s_mov_b32 s17, s5
  s_mov_b32 s18, 1605632
  s_mov_b32 s19, 0x20000
  s_mov_b32 s42, 0
  buffer_load_dwordx4 v[96:99], v8, s[16:19], s42 offen
  s_add_u32 s42, s42, 8192
  buffer_load_dwordx4 v[100:103], v8, s[16:19], s42 offen
  s_add_u32 s42, s42, 8192
  buffer_load_dwordx4 v[104:107], v8, s[16:19], s42 offen
  s_add_u32 s42, s42, 8192
  buffer_load_dwordx4 v[108:111], v8, s[16:19], s42 offen
  s_add_u32 s42, s42, 8192
  buffer_load_dwordx4 v[112:115], v8, s[16:19], s42 offen
  s_add_u32 s42, s42, 8192
  buffer_load_dwordx4 v[116:119], v8, s[16:19], s42 offen
  s_add_u32 s42, s42, 8192
  buffer_load_dwordx4 v[120:123], v8, s[16:19], s42 offen
  s_add_u32 s42, s42, 8192
  buffer_load_dwordx4 v[124:127], v8, s[16:19], s42 offen
  s_add_u32 s42, s42, 8192
  buffer_load_dwordx4 v[128:131], v8, s[16:19], s42 offen
  s_add_u32 s42, s42, 8192
  buffer_load_dwordx4 v[132:135], v8, s[16:19], s42 offen
  s_add_u32 s42, s42, 8192
  buffer_load_dwordx4 v[136:139], v8, s[16:19], s42 offen
  s_add_u32 s42, s42, 8192
  buffer_load_dwordx4 v[140:143], v8, s[16:19], s42 offen
  s_add_u32 s42, s42, 8192
  buffer_load_dwordx4 v[144:147], v8, s[16:19], s42 offen
  s_add_u32 s42, s42, 8192
  buffer_load_dwordx4 v[148:151], v8, s[16:19], s42 offen
  s_add_u32 s42, s42, 8192
  buffer_load_dwordx4 v[152:155], v8, s[16:19], s42 offen
  s_add_u32 s42, s42, 8192
  buffer_load_dwordx4 v[156:159], v8, s[16:19], s42 offen
  s_add_u32 s42, s42, 8192
  buffer_load_dwordx4 v[96:99], v8, s[16:19], s42 offen
  s_add_u32 s42, s42, 8192
  buffer_load_dwordx4 v[100:103], v8, s[16:19], s42 offen
  s_add_u32 s42, s42, 8192
  buffer_load_dwordx4 v[104:107], v8, s[16:19], s42 offen
  s_add_u32 s42, s42, 8192
  buffer_load_dwordx4 v[108:111], v8, s[16:19], s42 offen
  s_add_u32 s42, s42, 8192
  buffer_load_dwordx4 v[112:115], v8, s[16:19], s42 offen
  s_add_u32 s42, s42, 8192
  buffer_load_dwordx4 v[116:119], v8, s[16:19], s42 offen
  s_add_u32 s42, s42, 8192
  buffer_load_dwordx4 v[120:123], v8, s[16:19], s42 offen
  s_add_u32 s42, s42, 8192
  buffer_load_dwordx4 v[124:127], v8, s[16:19], s42 offen
  s_add_u32 s42, s42, 8192
  buffer_load_dwordx4 v[128:131], v8, s[16:19], s42 offen
  s_add_u32 s42, s42, 8192
  buffer_load_dwordx4 v[132:135], v8, s[16:19], s42 offen
  s_add_u32 s42, s42, 8192
  buffer_load_dwordx4 v[136:139], v8, s[16:19], s42 offen
  s_add_u32 s42, s42, 8192
  buffer_load_dwordx4 v[140:143], v8, s[16:19], s42 offen
  s_add_u32 s42, s42, 8192
  buffer_load_dwordx4 v[144:147], v8, s[16:19], s42 offen
  s_add_u32 s42, s42, 8192
  buffer_load_dwordx4 v[148:151], v8, s[16:19], s42 offen
  s_add_u32 s42, s42, 8192
  buffer_load_dwordx4 v[152:155], v8, s[16:19], s42 offen
  s_add_u32 s42, s42, 8192
  buffer_load_dwordx4 v[156:159], v8, s[16:19], s42 offen
  s_add_u32 s42, s42, 8192
  buffer_load_dwordx4 v[96:99], v8, s[16:19], s42 offen
  s_add_u32 s42, s42, 8192
  buffer_load_dwordx4 v[100:103], v8, s[16:19], s42 offen
  s_add_u32 s42, s42, 8192
  buffer_load_dwordx4 v[104:107], v8, s[16:19], s42 offen
  s_add_u32 s42, s42, 8192
  buffer_load_dwordx4 v[108:111], v8, s[16:19], s42 offen
  s_add_u32 s42, s42, 8192
  buffer_load_dwordx4 v[112:115], v8, s[16:19], s42 offen
  s_add_u32 s42, s42, 8192
  buffer_load_dwordx4 v[116:119], v8, s[16:19], s42 offen
  s_add_u32 s42, s42, 8192
  buffer_load_dwordx4 v[120:123], v8, s[16:19], s42 offen
  s_add_u32 s42, s42, 8192
  buffer_load_dwordx4 v[124:127], v8, s[16:19], s42 offen
  s_add_u32 s42, s42, 8192
  buffer_load_dwordx4 v[128:131], v8, s[16:19], s42 offen
  s_add_u32 s42, s42, 8192
  buffer_load_dwordx4 v[132:135], v8, s[16:19], s42 offen
  s_add_u32 s42, s42, 8192
  buffer_load_dwordx4 v[136:139], v8, s[16:19], s42 offen
  s_add_u32 s42, s42, 8192
  buffer_load_dwordx4 v[140:143], v8, s[16:19], s42 offen
  s_add_u32 s42, s42, 8192
  buffer_load_dwordx4 v[144:147], v8, s[16:19], s42 offen
  s_add_u32 s42, s42, 8192
  buffer_load_dwordx4 v[148:151], v8, s[16:19], s42 offen
  s_add_u32 s42, s42, 8192
  buffer_load_dwordx4 v[152:155], v8, s[16:19], s42 offen
  s_add_u32 s42, s42, 8192
  buffer_load_dwordx4 v[156:159], v8, s[16:19], s42 offen
  s_add_u32 s42, s42, 8192
  buffer_load_dwordx4 v[96:99], v8, s[16:19], s42 offen
  s_add_u32 s42, s42, 8192
  s_waitcnt vmcnt(0)
  s_branch L_kall_end
L_kall_end:
L_kall_last:
  s_endpgm
.section .rodata,"a"
.p2align 6
.amdhsa_kernel sequential_preLN__ssm_conv_s4__glu_gated_glu__prompt_kernel
  .amdhsa_next_free_vgpr 256
  .amdhsa_next_free_sgpr 100
  .amdhsa_accum_offset 256
  .amdhsa_group_segment_fixed_size 0
  .amdhsa_kernarg_size 128
  .amdhsa_user_sgpr_count 2
  .amdhsa_user_sgpr_kernarg_segment_ptr 1
  .amdhsa_system_sgpr_workgroup_id_x 1
  .amdhsa_float_denorm_mode_32 3
.end_amdhsa_kernel
.text
```
